```python
import torch

def _softmax(x, axis=-1):
    return torch.softmax(x, dim=axis)
def _gelu(x):
    return torch.nn.functional.gelu(x, approximate="tanh")
def _silu(x):
    return torch.nn.functional.silu(x)
def _sigmoid(x):
    return torch.sigmoid(x)
def _layernorm(x, axis=-1, eps=1e-5):
    m = x.mean(dim=axis, keepdim=True)
    v = x.var(dim=axis, keepdim=True, unbiased=False)
    return (x - m) / torch.sqrt(v + eps)
def _scatter_add(tgt, idx, src, axis=0):
    return tgt.clone().index_add_(axis, idx, src)
def _segment_sum(src, seg, n):
    out = torch.zeros((n,) + src.shape[1:], dtype=src.dtype)
    return out.index_add_(0, seg, src)
def _pad(x, pw):
    flat = tuple(v for pair in reversed(pw) for v in pair)
    return torch.nn.functional.pad(x, flat)

kernel_name = 'concat_heads__mha_block__ssm_conv_h3__prompt'

def setup_inputs():

    _w = (lambda a: (lambda t: t.to(torch.bfloat16) if t.is_floating_point() else t)(torch.as_tensor(a)))
    def _A_setup():
        B, S, D, H = 1, 2048, 512, 32
        return {
            "x": _w((lambda *s: torch.randn(*s, dtype=torch.bfloat16) * 0.2)(B, S, D)),
            "wqkv": _w((lambda *s: torch.randn(*s, dtype=torch.bfloat16) * 0.2)(D, 3 * D)),
            "wo": _w((lambda *s: torch.randn(*s, dtype=torch.bfloat16) * 0.05)(D, D)),
        }
    _A_in = _A_setup()

    def _B_setup():
        B, S, D = 1, 2048, 512
        ks = 4
        return {
            "q": _w((lambda *s: torch.randn(*s, dtype=torch.bfloat16) * 0.05)(B, S, D)),
            "k": _w((lambda *s: torch.randn(*s, dtype=torch.bfloat16) * 0.4)(B, S, D)),
            "v": _w((lambda *s: torch.randn(*s, dtype=torch.bfloat16) * 0.4)(B, S, D)),
            "shift_k": _w((lambda *s: torch.randn(*s, dtype=torch.bfloat16) * 0.4)(D, ks) * 0.5),
            "ssm_k": _w((lambda *s: torch.randn(*s, dtype=torch.bfloat16) * 0.8)(D, S) * (1.0 / S ** 0.5)),
            "ssm_D": _w((lambda *s: torch.randn(*s, dtype=torch.bfloat16) * 0.4)(D)),
        }
    _B_in = _B_setup()

    return {
        "A_x": _A_in["x"],
        "A_wqkv": _A_in["wqkv"],
        "A_wo": _A_in["wo"],
        "B_q": _B_in["q"],
        "B_k": _B_in["k"],
        "B_v": _B_in["v"],
        "B_shift_k": _B_in["shift_k"],
        "B_ssm_k": _B_in["ssm_k"],
        "B_ssm_D": _B_in["ssm_D"],
    }

def reference(A_x, A_wqkv, A_wo, B_q, B_k, B_v, B_shift_k, B_ssm_k, B_ssm_D):
    def _A_ref(x, wqkv, wo):
        B, S, D = x.shape
        H = 32
        Dh = D // H
        qkv = (lambda x, *d: x.permute(*d))((x @ wqkv).reshape(B, S, 3, H, Dh), 2, 0, 3, 1, 4)
        q, k, v = qkv[0], qkv[1], qkv[2]
        scores = torch.einsum("bhqd,bhkd->bhqk", q, k) * (Dh ** -0.5)
        p = _softmax(scores, axis=-1)
        o = torch.einsum("bhqk,bhkd->bhqd", p, v)
        return (lambda x, *d: x.permute(*d))(o, 0, 2, 1, 3).reshape(B, S, D) @ wo

    def _B_ref(q, k, v, shift_k, ssm_k, ssm_D):
        B, S, D = q.shape
        ks = shift_k.shape[-1]
        k_pad = _pad(k, ((0, 0), (ks - 1, 0), (0, 0)))
        k_shift = torch.zeros_like(k)
        for t in range(ks):
            k_shift = k_shift + k_pad[:, t:t + S, :] * shift_k[:, ks - 1 - t][None, None, :]
        kv = k_shift * v
        L = 2 * S
        kv_pad = _pad(kv, ((0, 0), (0, S), (0, 0)))
        kf_pad = _pad(ssm_k, ((0, 0), (0, S)))
        kv_f = (lambda x, axes=(-2,-1): torch.fft.rfft2(x.float(), dim=axes))(kv_pad[:, None, :, :], axes=(1, 2))
        kf_f = (lambda x, axes=(-2,-1): torch.fft.rfft2(x.float(), dim=axes))(kf_pad[:, None, :], axes=(1, 2))
        kf_f = (lambda x, *d: x.permute(*d))(kf_f, 1, 2, 0)
        y_f = kv_f * kf_f[None, :, :, :]
        y = (lambda x, s, axes=(-2,-1): torch.fft.irfft2(x, s=s, dim=axes).to(torch.bfloat16))(y_f, (1, L), axes=(1, 2))[:, 0, :S, :]
        y = y + kv * ssm_D[None, None, :]
        return q * y

    a = _A_ref(A_x, A_wqkv, A_wo)
    b = _B_ref(B_q, B_k, B_v, B_shift_k, B_ssm_k, B_ssm_D)
    return torch.concatenate([a, b], axis=-1)
```

```asm
; @launch grid=(256,1,1) block=(512,1,1) lds=163840
.amdgcn_target "amdgcn-amd-amdhsa--gfx950"
.text
.globl concat_heads__mha_block__ssm_conv_h3__prompt_kernel
.p2align 8
.type concat_heads__mha_block__ssm_conv_h3__prompt_kernel,@function
concat_heads__mha_block__ssm_conv_h3__prompt_kernel:
    s_cmp_ge_u32 s2, 0x100
    s_cbranch_scc1 L_end
    s_load_dwordx2 s[4:5], s[0:1], 0
    s_load_dwordx2 s[8:9], s[0:1], 8
    s_load_dwordx2 s[44:45], s[0:1], 88
    s_getpc_b64 s[88:89]
L_pc:
    s_lshr_b32 s52, s2, 3
    s_and_b32 s49, s2, 7
    v_lshrrev_b32 v6, 6, v0
    v_lshl_add_u32 v7, s52, 3, v6
    v_lshlrev_b32 v7, 7, v7
    v_min_u32 v7, L_end-L_pc, v7
    global_load_dword v4, v7, s[88:89]
    v_readfirstlane_b32 s48, v6
    s_add_u32 s53, s49, s52
    s_xor_b32 s51, s49, 4
    v_min_u32 v6, 47, v0
    s_mul_i32 s57, s52, 48*8
    s_add_u32 s57, s57, s49
    v_lshl_add_u32 v6, v6, 3, s57
    v_lshlrev_b32 v6, 7, v6
    s_cmp_lg_u32 s48, 0
    s_cbranch_scc1 L_nopf
    s_waitcnt lgkmcnt(0)
    global_load_dword v57, v6, s[8:9]
L_nopf:
    s_mov_b32 s7, 0x20000
    s_and_b32 s72, s48, 3
    s_cmp_lt_u32 s48, 4
    s_cbranch_scc1 L_main
    v_and_b32 v0, 0xff, v0
    s_mov_b32 s6, 0x200000
    s_mov_b32 s10, 0x180000
    s_mov_b32 s11, s7
    v_lshrrev_b32 v6, 4, v0
    v_xor_b32 v32, v6, v0
    v_and_b32 v32, 15, v32
    v_lshl_add_u32 v6, s52, 6, v6
    v_lshlrev_b32 v6, 10, v6
    v_lshl_add_u32 v48, v32, 4, v6
    v_lshrrev_b32 v6, 2, v0
    v_and_b32 v6, 4, v6
    v_xor_b32 v6, v6, v0
    v_and_b32 v6, 7, v6
    v_lshl_add_u32 v6, s49, 3, v6
    v_lshrrev_b32 v32, 3, v0
    v_mul_u32_u24 v32, 0xc00, v32
    v_lshl_add_u32 v49, v6, 4, v32
    s_lshl_b32 s63, s72, 10
    s_and_b32 s57, s53, 3
    s_mul_i32 s62, s57, 393216
    s_add_u32 m0, s63, 16384
    s_add_u32 s59, s62, 1024
    s_waitcnt lgkmcnt(0)
    buffer_load_dwordx4 v49, s[8:11], s59 offen lds
    s_addk_i32 m0, 0x1000
    s_add_u32 s59, s59, 98304
    buffer_load_dwordx4 v49, s[8:11], s59 offen lds
    s_add_u32 m0, s63, 32768
    s_add_u32 s59, s62, 2048
    buffer_load_dwordx4 v49, s[8:11], s59 offen lds
    s_addk_i32 m0, 0x1000
    s_add_u32 s59, s59, 98304
    buffer_load_dwordx4 v49, s[8:11], s59 offen lds
    s_and_b32 s57, s53, 3
    s_lshl_b32 s61, s57, 8
    s_add_u32 m0, s63, 0
    s_add_u32 s59, s61, 0
    buffer_load_dwordx4 v48, s[4:7], s59 offen lds
    s_addk_i32 m0, 0x1000
    s_add_u32 s59, s59, 16384
    buffer_load_dwordx4 v48, s[4:7], s59 offen lds
    s_addk_i32 m0, 0x1000
    s_add_u32 s59, s59, 16384
    buffer_load_dwordx4 v48, s[4:7], s59 offen lds
    s_addk_i32 m0, 0x1000
    s_add_u32 s59, s59, 16384
    buffer_load_dwordx4 v48, s[4:7], s59 offen lds
    s_add_u32 m0, s63, 24576
    s_add_u32 s59, s62, 197632
    buffer_load_dwordx4 v49, s[8:11], s59 offen lds
    s_addk_i32 m0, 0x1000
    s_add_u32 s59, s59, 98304
    buffer_load_dwordx4 v49, s[8:11], s59 offen lds
    s_add_u32 m0, s63, 40960
    s_add_u32 s59, s62, 198656
    buffer_load_dwordx4 v49, s[8:11], s59 offen lds
    s_addk_i32 m0, 0x1000
    s_add_u32 s59, s59, 98304
    buffer_load_dwordx4 v49, s[8:11], s59 offen lds
    s_load_dwordx8 s[80:87], s[0:1], 16
    s_load_dwordx8 s[92:99], s[0:1], 48
    v_and_b32 v1, 63, v0
    s_add_u32 s88, s44, 10616832
    s_addc_u32 s89, s45, 0
    s_load_dword s54, s[88:89], 0
    s_mov_b32 s46, 0xa50000
    s_mov_b32 s47, s7
    s_and_b32 s3, s48, 1
    s_bfe_u32 s69, s48, 0x10001
    v_and_b32 v5, 31, v0
    v_lshlrev_b32 v5, 2, v5
    v_mov_b32 v2, 142848
    v_mov_b32 v3, 1
    s_mov_b32 s73, 0
    s_mov_b32 s55, 0xffff0000
    v_lshrrev_b32 v53, 5, v0
    v_lshrrev_b32 v6, 3, v1
    v_and_b32 v7, 7, v1
    v_lshlrev_b32 v7, 4, v7
    v_lshl_add_u32 v8, v6, 10, v7
    v_cmp_gt_u32 vcc, 5, v6
    s_lshl_b32 s68, s72, 13
    s_add_u32 s68, s68, 49152
    v_lshrrev_b32 v6, 5, v1
    v_lshl_add_u32 v6, v6, 10, v5
    v_add_u32 v15, s68, v6
    v_lshl_add_u32 v41, v53, 14, v5
    s_lshl_b32 s56, s52, 16
    s_lshl_b32 s57, s51, 7
    s_add_u32 s56, s56, s57
    s_lshl4_add_u32 s56, s63, s56
    s_sub_u32 s59, s56, 0x2000
    v_add_u32 v6, s59, v8
    v_bfrev_b32 v7, 2
    v_cndmask_b32 v9, v6, v7, vcc
    v_lshlrev_b32 v10, 2, v5
    v_xor_b32 v6, 7, v53
    v_xor_b32 v6, v6, v0
    v_and_b32 v6, 7, v6
    v_lshlrev_b32 v6, 4, v6
    v_lshl_add_u32 v11, v5, 5, v6
    v_lshrrev_b32 v7, 1, v0
    v_xor_b32 v7, v53, v7
    v_and_b32 v7, 7, v7
    v_lshlrev_b32 v7, 4, v7
    v_lshl_add_u32 v7, v5, 5, v7
    v_add_u32 v40, 131072, v7
    v_lshrrev_b32 v6, 3, v0
    v_xor_b32 v7, v6, v0
    v_and_b32 v7, 7, v7
    v_lshlrev_b32 v7, 4, v7
    v_lshl_add_u32 v12, v6, 7, v7
    v_and_b32 v7, 7, v0
    v_lshlrev_b32 v7, 4, v7
    v_lshl_add_u32 v13, v6, 13, v7
    v_lshrrev_b32 v7, 1, v6
    v_xor_b32 v7, v7, v0
    v_and_b32 v7, 7, v7
    v_lshlrev_b32 v7, 4, v7
    v_lshl_add_u32 v37, v6, 13, v7
    v_lshlrev_b32 v14, 4, v0
    v_add_u32 v32, 98688, v14
    v_and_b32 v6, 3, v1
    v_mul_u32_u24 v6, 4512, v6
    v_bfe_u32 v53, v1, 2, 2
    v_lshl_add_u32 v6, v53, 7, v6
    v_and_b32 v7, 0x30, v1
    v_add_u32 v6, v6, v7
    s_mul_i32 s57, s3, 18048
    s_lshl_b32 s58, s69, 8
    s_add_u32 s57, s57, s58
    s_add_u32 s57, s57, 98304
    v_add_u32 v33, s57, v6
    v_and_b32 v6, 15, v1
    v_lshlrev_b32 v6, 3, v6
    v_sub_u32 v6, v7, v6
    s_mul_i32 s64, s3, 4224
    s_add_u32 s64, s64, 134400
    s_add_u32 s57, s64, s58
    s_add_u32 s57, s57, 120
    v_add_u32 v34, s57, v6
    v_lshlrev_b32 v35, 4, v1
    v_lshlrev_b32 v46, 3, v1
    v_lshlrev_b32 v51, 9, v1
    v_lshl_add_u32 v44, s72, 12, v35
    v_xor_b32 v45, 0x2000, v44
    v_add_u32 v44, 143360, v44
    v_add_u32 v45, 143360, v45
    v_min_u32 v6, 23, v1
    s_mul_i32 s57, s72, 4512
    s_add_u32 s57, s57, 98304
    v_lshl_add_u32 v47, v6, 4, s57
    v_and_b32 v6, 7, v1
    v_lshl_add_u32 v50, v6, 4, s64
    s_lshl_b32 s57, s51, 5
    s_add_u32 s57, s57, s52
    s_lshl_b32 s66, s57, 13
    v_lshrrev_b32 v6, 4, v0
    v_lshlrev_b32 v7, 2, v6
    v_xor_b32 v7, v7, v0
    v_and_b32 v7, 15, v7
    v_lshlrev_b32 v7, 4, v7
    v_lshl_add_u32 v6, v6, 10, v7
    s_and_b32 s57, s52, 3
    v_lshl_add_u32 v36, s57, 8, v6
    v_lshrrev_b32 v7, 5, v1
    v_lshl_add_u32 v7, v7, 2, v53
    v_xor_b32 v6, s72, v53
    v_lshlrev_b32 v6, 6, v6
    v_lshl_add_u32 v6, v7, 8, v6
    v_and_b32 v7, 1, v1
    v_lshl_add_u32 v6, v7, 5, v6
    v_and_b32 v7, 16, v1
    v_add_u32 v6, v6, v7
    v_and_b32 v7, 2, v1
    v_lshl_add_u32 v38, v7, 2, v6
    v_add_u32 v39, 0x10000, v38
    v_and_b32 v42, 28, v5
    v_lshrrev_b32 v6, 4, v1
    v_and_b32 v6, 2, v6
    v_lshrrev_b32 v7, 1, v1
    v_xor_b32 v6, v6, v7
    v_and_b32 v6, 3, v6
    v_lshlrev_b32 v6, 4, v6
    v_lshl_add_u32 v6, v5, 4, v6
    s_lshl_b32 s57, s72, 11
    s_add_u32 s57, s57, 143360
    v_add_u32 v54, s57, v6
    v_lshrrev_b32 v6, 3, v1
    v_xor_b32 v6, v6, v1
    v_and_b32 v6, 3, v6
    v_and_b32 v7, 0x3c, v1
    v_or_b32 v6, v6, v7
    v_lshl_add_u32 v55, v6, 4, s57
    v_and_b32 v6, 3, v1
    v_lshlrev_b32 v6, 4, v6
    v_lshl_add_u32 v43, v7, 9, v6
    v_mov_b64 v[64:65], 0
    v_mov_b64 v[66:67], 0
    v_mov_b64 v[68:69], 0
    v_mov_b64 v[70:71], 0
    v_mov_b64 v[72:73], 0
    v_mov_b64 v[74:75], 0
    v_mov_b64 v[76:77], 0
    v_mov_b64 v[78:79], 0
    v_mov_b64 v[80:81], 0
    v_mov_b64 v[82:83], 0
    v_mov_b64 v[84:85], 0
    v_mov_b64 v[86:87], 0
    v_mov_b64 v[88:89], 0
    v_mov_b64 v[90:91], 0
    v_mov_b64 v[92:93], 0
    v_mov_b64 v[94:95], 0
    v_mov_b64 v[160:161], 0
    v_mov_b64 v[162:163], 0
    v_mov_b64 v[164:165], 0
    v_mov_b64 v[166:167], 0
    v_mov_b64 v[168:169], 0
    v_mov_b64 v[170:171], 0
    v_mov_b64 v[172:173], 0
    v_mov_b64 v[174:175], 0
    v_mov_b64 v[176:177], 0
    v_mov_b64 v[178:179], 0
    v_mov_b64 v[180:181], 0
    v_mov_b64 v[192:193], 0
    v_mov_b64 v[194:195], 0
    v_mov_b64 v[196:197], 0
    v_mov_b64 v[198:199], 0
    v_mov_b64 v[200:201], 0
    v_mov_b64 v[202:203], 0
    v_mov_b64 v[204:205], 0
    v_mov_b64 v[206:207], 0
    s_waitcnt lgkmcnt(0)
    s_mov_b64 s[12:13], s[80:81]
    s_mov_b64 s[16:17], s[82:83]
    s_mov_b64 s[20:21], s[84:85]
    s_mov_b64 s[24:25], s[86:87]
    s_mov_b64 s[28:29], s[92:93]
    s_mov_b64 s[32:33], s[94:95]
    s_mov_b64 s[36:37], s[96:97]
    s_mov_b64 s[40:41], s[98:99]
    s_mov_b64 s[22:23], s[6:7]
    s_mov_b64 s[26:27], s[6:7]
    s_mov_b64 s[34:35], s[6:7]
    s_mov_b64 s[18:19], s[6:7]
    s_mov_b32 s30, 0x1000
    s_mov_b32 s31, s7
    s_mov_b32 s38, 0x400
    s_mov_b32 s39, s7
    s_mov_b32 s14, 0x80000
    s_mov_b32 s15, s7
    s_mov_b32 s42, 0x400000
    s_mov_b32 s43, s7
    s_mul_i32 s54, s54, 0x2c9277b5
    s_add_u32 s54, s54, 0xac564b05
    v_mov_b32 v52, s54
    s_mov_b32 s70, s54
    s_mov_b32 s71, s54
    s_lshl_b32 s57, s51, 7
    s_lshl_b32 s58, s51, 9
    buffer_load_dwordx4 v[148:151], v10, s[28:31], s58 offen
    buffer_load_dword v139, v5, s[36:39], s57 offen
    s_add_u32 s57, s53, 1
    s_and_b32 s57, s57, 3
    s_lshl_b32 s61, s57, 8
    s_add_u32 m0, s63, 49152
    s_add_u32 s59, s61, 0
    buffer_load_dwordx4 v48, s[4:7], s59 offen lds
    s_addk_i32 m0, 0x1000
    s_add_u32 s59, s59, 16384
    buffer_load_dwordx4 v48, s[4:7], s59 offen lds
    s_addk_i32 m0, 0x1000
    s_add_u32 s59, s59, 16384
    buffer_load_dwordx4 v48, s[4:7], s59 offen lds
    s_addk_i32 m0, 0x1000
    s_add_u32 s59, s59, 16384
    buffer_load_dwordx4 v48, s[4:7], s59 offen lds
    s_add_u32 s57, s53, 1
    s_and_b32 s57, s57, 3
    s_mul_i32 s62, s57, 393216
    s_add_u32 m0, s63, 65536
    s_add_u32 s59, s62, 1024
    buffer_load_dwordx4 v49, s[8:11], s59 offen lds
    s_addk_i32 m0, 0x1000
    s_add_u32 s59, s59, 98304
    buffer_load_dwordx4 v49, s[8:11], s59 offen lds
    s_add_u32 m0, s63, 81920
    s_add_u32 s59, s62, 2048
    buffer_load_dwordx4 v49, s[8:11], s59 offen lds
    s_addk_i32 m0, 0x1000
    s_add_u32 s59, s59, 98304
    buffer_load_dwordx4 v49, s[8:11], s59 offen lds
    s_waitcnt vmcnt(12)
    s_barrier
    s_add_u32 m0, s63, 73728
    s_add_u32 s59, s62, 197632
    buffer_load_dwordx4 v49, s[8:11], s59 offen lds
    s_addk_i32 m0, 0x1000
    s_add_u32 s59, s59, 98304
    buffer_load_dwordx4 v49, s[8:11], s59 offen lds
    s_add_u32 m0, s63, 90112
    s_add_u32 s59, s62, 198656
    buffer_load_dwordx4 v49, s[8:11], s59 offen lds
    s_addk_i32 m0, 0x1000
    s_add_u32 s59, s59, 98304
    buffer_load_dwordx4 v49, s[8:11], s59 offen lds
    s_waitcnt vmcnt(12)
    s_barrier
    s_add_u32 s57, s53, 2
    s_and_b32 s57, s57, 3
    s_lshl_b32 s61, s57, 8
    s_add_u32 m0, s63, 98304
    s_add_u32 s59, s61, 0
    buffer_load_dwordx4 v48, s[4:7], s59 offen lds
    s_addk_i32 m0, 0x1000
    s_add_u32 s59, s59, 16384
    buffer_load_dwordx4 v48, s[4:7], s59 offen lds
    s_addk_i32 m0, 0x1000
    s_add_u32 s59, s59, 16384
    buffer_load_dwordx4 v48, s[4:7], s59 offen lds
    s_addk_i32 m0, 0x1000
    s_add_u32 s59, s59, 16384
    buffer_load_dwordx4 v48, s[4:7], s59 offen lds
    s_add_u32 s57, s53, 2
    s_and_b32 s57, s57, 3
    s_mul_i32 s62, s57, 393216
    s_add_u32 m0, s63, 114688
    s_add_u32 s59, s62, 1024
    buffer_load_dwordx4 v49, s[8:11], s59 offen lds
    s_addk_i32 m0, 0x1000
    s_add_u32 s59, s59, 98304
    buffer_load_dwordx4 v49, s[8:11], s59 offen lds
    s_add_u32 m0, s63, 131072
    s_add_u32 s59, s62, 2048
    buffer_load_dwordx4 v49, s[8:11], s59 offen lds
    s_addk_i32 m0, 0x1000
    s_add_u32 s59, s59, 98304
    buffer_load_dwordx4 v49, s[8:11], s59 offen lds
    s_waitcnt vmcnt(12)
    s_barrier
    s_add_u32 m0, s63, 122880
    s_add_u32 s59, s62, 197632
    buffer_load_dwordx4 v49, s[8:11], s59 offen lds
    s_addk_i32 m0, 0x1000
    s_add_u32 s59, s59, 98304
    buffer_load_dwordx4 v49, s[8:11], s59 offen lds
    s_add_u32 m0, s63, 139264
    s_add_u32 s59, s62, 198656
    buffer_load_dwordx4 v49, s[8:11], s59 offen lds
    s_addk_i32 m0, 0x1000
    s_add_u32 s59, s59, 98304
    buffer_load_dwordx4 v49, s[8:11], s59 offen lds
    s_waitcnt vmcnt(12)
    s_barrier
    s_add_u32 s57, s53, 3
    s_and_b32 s57, s57, 3
    s_mul_i32 s62, s57, 393216
    s_add_u32 m0, s63, 16384
    s_add_u32 s59, s62, 1024
    buffer_load_dwordx4 v49, s[8:11], s59 offen lds
    s_addk_i32 m0, 0x1000
    s_add_u32 s59, s59, 98304
    buffer_load_dwordx4 v49, s[8:11], s59 offen lds
    s_add_u32 m0, s63, 32768
    s_add_u32 s59, s62, 2048
    buffer_load_dwordx4 v49, s[8:11], s59 offen lds
    s_addk_i32 m0, 0x1000
    s_add_u32 s59, s59, 98304
    buffer_load_dwordx4 v49, s[8:11], s59 offen lds
    s_add_u32 s57, s53, 3
    s_and_b32 s57, s57, 3
    s_lshl_b32 s61, s57, 8
    s_add_u32 m0, s63, 147456
    s_add_u32 s59, s61, 0
    buffer_load_dwordx4 v48, s[4:7], s59 offen lds
    s_addk_i32 m0, 0x1000
    s_add_u32 s59, s59, 16384
    buffer_load_dwordx4 v48, s[4:7], s59 offen lds
    s_addk_i32 m0, 0x1000
    s_add_u32 s59, s59, 16384
    buffer_load_dwordx4 v48, s[4:7], s59 offen lds
    s_addk_i32 m0, 0x1000
    s_add_u32 s59, s59, 16384
    buffer_load_dwordx4 v48, s[4:7], s59 offen lds
    s_waitcnt vmcnt(12)
    s_barrier
    s_add_u32 m0, s63, 24576
    s_add_u32 s59, s62, 197632
    buffer_load_dwordx4 v49, s[8:11], s59 offen lds
    s_addk_i32 m0, 0x1000
    s_add_u32 s59, s59, 98304
    buffer_load_dwordx4 v49, s[8:11], s59 offen lds
    s_add_u32 m0, s63, 40960
    s_add_u32 s59, s62, 198656
    buffer_load_dwordx4 v49, s[8:11], s59 offen lds
    s_addk_i32 m0, 0x1000
    s_add_u32 s59, s59, 98304
    buffer_load_dwordx4 v49, s[8:11], s59 offen lds
    s_waitcnt vmcnt(12)
    s_barrier
    s_and_b32 s57, s53, 3
    s_mul_i32 s62, s57, 393216
    s_add_u32 m0, s63, 0
    s_add_u32 s59, s62, 0
    buffer_load_dwordx4 v49, s[8:11], s59 offen lds
    s_addk_i32 m0, 0x1000
    s_add_u32 s59, s59, 98304
    buffer_load_dwordx4 v49, s[8:11], s59 offen lds
    s_addk_i32 m0, 0x1000
    s_add_u32 s59, s59, 98304
    buffer_load_dwordx4 v49, s[8:11], s59 offen lds
    s_addk_i32 m0, 0x1000
    s_add_u32 s59, s59, 98304
    buffer_load_dwordx4 v49, s[8:11], s59 offen lds
    s_add_u32 s57, s53, 1
    s_and_b32 s57, s57, 3
    s_mul_i32 s62, s57, 393216
    s_add_u32 m0, s63, 49152
    s_add_u32 s59, s62, 0
    buffer_load_dwordx4 v49, s[8:11], s59 offen lds
    s_addk_i32 m0, 0x1000
    s_add_u32 s59, s59, 98304
    buffer_load_dwordx4 v49, s[8:11], s59 offen lds
    s_addk_i32 m0, 0x1000
    s_add_u32 s59, s59, 98304
    buffer_load_dwordx4 v49, s[8:11], s59 offen lds
    s_addk_i32 m0, 0x1000
    s_add_u32 s59, s59, 98304
    buffer_load_dwordx4 v49, s[8:11], s59 offen lds
    s_waitcnt vmcnt(12)
    s_barrier
    s_waitcnt vmcnt(8)
    s_barrier
    s_add_u32 s57, s53, 2
    s_and_b32 s57, s57, 3
    s_mul_i32 s62, s57, 393216
    s_add_u32 m0, s63, 65536
    s_add_u32 s59, s62, 0
    buffer_load_dwordx4 v49, s[8:11], s59 offen lds
    s_addk_i32 m0, 0x1000
    s_add_u32 s59, s59, 98304
    buffer_load_dwordx4 v49, s[8:11], s59 offen lds
    s_addk_i32 m0, 0x1000
    s_add_u32 s59, s59, 98304
    buffer_load_dwordx4 v49, s[8:11], s59 offen lds
    s_addk_i32 m0, 0x1000
    s_add_u32 s59, s59, 98304
    buffer_load_dwordx4 v49, s[8:11], s59 offen lds
    s_add_u32 s57, s53, 3
    s_and_b32 s57, s57, 3
    s_mul_i32 s62, s57, 393216
    s_add_u32 m0, s63, 81920
    s_add_u32 s59, s62, 0
    buffer_load_dwordx4 v49, s[8:11], s59 offen lds
    s_addk_i32 m0, 0x1000
    s_add_u32 s59, s59, 98304
    buffer_load_dwordx4 v49, s[8:11], s59 offen lds
    s_addk_i32 m0, 0x1000
    s_add_u32 s59, s59, 98304
    buffer_load_dwordx4 v49, s[8:11], s59 offen lds
    s_addk_i32 m0, 0x1000
    s_add_u32 s59, s59, 98304
    buffer_load_dwordx4 v49, s[8:11], s59 offen lds
    s_waitcnt vmcnt(8)
    s_barrier
    s_lshr_b32 s57, s52, 3
    s_mul_i32 s57, s57, 96
    s_lshl2_add_u32 s57, s52, s57
    s_lshl_b32 s60, s49, 11
    s_add_u32 s60, s60, 10518528
    s_add_u32 s57, s57, s60
    s_waitcnt vmcnt(0)
    s_barrier
    s_cmp_lg_u32 s48, 4
    s_cbranch_scc1 L_ow1
    s_mov_b64 exec, 0xf
    buffer_store_dword v52, v51, s[44:47], s57 offen sc1
    s_mov_b64 exec, -1
L_ow1:
    v_lshlrev_b32 v184, 16, v148
    v_lshlrev_b32 v185, 16, v150
    v_and_b32 v186, s55, v148
    v_and_b32 v187, s55, v150
    v_lshlrev_b32 v188, 16, v149
    v_lshlrev_b32 v189, 16, v151
    v_and_b32 v190, s55, v149
    v_and_b32 v191, s55, v151
    v_lshlrev_b32 v48, 16, v139
    v_and_b32 v49, s55, v139
    s_lshr_b32 s58, s52, 3
    s_lshl2_add_u32 s58, s58, s72
    s_lshl_b32 s58, s58, 7
    s_add_u32 s60, s60, s58
    s_barrier
    s_mov_b32 s67, 0
    s_load_dwordx8 s[4:11], s[44:45], s60 glc
    s_barrier
    s_branch L_spoll2b
L_spoll2:
    s_load_dwordx8 s[4:11], s[44:45], s60 glc
L_spoll2b:
    s_add_u32 s67, s67, 1
    s_cmp_ge_u32 s67, 16384
    s_waitcnt lgkmcnt(0)
    s_cbranch_scc1 L_spollok3
    s_xor_b64 s[4:5], s[4:5], s[70:71]
    s_xor_b64 s[6:7], s[6:7], s[70:71]
    s_xor_b64 s[8:9], s[8:9], s[70:71]
    s_xor_b64 s[10:11], s[10:11], s[70:71]
    s_or_b64 s[4:5], s[4:5], s[6:7]
    s_or_b64 s[8:9], s[8:9], s[10:11]
    s_or_b64 s[4:5], s[4:5], s[8:9]
    s_cbranch_scc0 L_spollok3
    s_sleep 1
    s_branch L_spoll2
L_spollok3:
    s_barrier
    s_setprio 3
    s_add_u32 s73, s73, 8
    s_mov_b64 exec, 1
    ds_add_u32 v2, v3
L_hb4:
    ds_read_b32 v6, v2
    s_waitcnt lgkmcnt(0)
    v_cmp_gt_u32 vcc, s73, v6
    s_cbranch_vccz L_hb4x
    s_sleep 1
    s_branch L_hb4
L_hb4x:
    s_mov_b64 exec, -1
    s_add_u32 s59, s56, 0x2000
    s_add_u32 s58, s66, 0x1000
    s_add_u32 m0, s68, 1024
    s_nop 0
    buffer_load_dwordx4 v8, s[20:23], s56 offen lds
    s_add_u32 m0, s68, 2048
    s_nop 0
    buffer_load_dwordx4 v8, s[20:23], s59 offen lds
    s_waitcnt vmcnt(1)
    s_add_u32 m0, s68, 0
    s_nop 0
    buffer_load_dwordx4 v9, s[20:23], 0 offen lds
    ds_write_b128 v47, v[64:67]
    ds_write_b128 v47, v[64:67] offset:18048
    ds_write_b128 v50, v[64:67] offset:4096
    s_waitcnt vmcnt(1)
    s_add_u32 m0, s68, 3072
    s_nop 0
    buffer_load_dwordx4 v8, s[24:27], s56 offen lds
    s_waitcnt vmcnt(1)
    s_add_u32 m0, s68, 4096
    s_nop 0
    buffer_load_dwordx4 v8, s[24:27], s59 offen lds
    s_waitcnt vmcnt(2)
    ds_read_u16_d16_hi v160, v15 offset:640
    ds_read_u16_d16_hi v161, v15 offset:642
    ds_read_u16_d16_hi v162, v15 offset:768
    ds_read_u16_d16_hi v163, v15 offset:770
    ds_read_u16_d16_hi v164, v15 offset:896
    ds_read_u16_d16_hi v165, v15 offset:898
    ds_read_u16_d16_hi v166, v15 offset:1024
    ds_read_u16_d16_hi v167, v15 offset:1026
    ds_read_u16_d16_hi v168, v15 offset:1152
    ds_read_u16_d16_hi v169, v15 offset:1154
    ds_read_u16_d16_hi v170, v15 offset:1280
    ds_read_u16_d16_hi v171, v15 offset:1282
    ds_read_u16_d16_hi v172, v15 offset:1408
    ds_read_u16_d16_hi v173, v15 offset:1410
    ds_read_u16_d16_hi v174, v15 offset:1536
    ds_read_u16_d16_hi v175, v15 offset:1538
    ds_read_u16_d16_hi v176, v15 offset:1664
    ds_read_u16_d16_hi v177, v15 offset:1666
    ds_read_u16_d16_hi v178, v15 offset:1792
    ds_read_u16_d16_hi v179, v15 offset:1794
    ds_read_u16_d16_hi v180, v15 offset:1920
    ds_read_u16_d16_hi v181, v15 offset:1922
    s_waitcnt vmcnt(1)
    s_add_u32 m0, s63, 112224
    s_nop 0
    buffer_load_dwordx4 v14, s[32:35], s66 offen lds
    s_waitcnt vmcnt(1)
    s_add_u32 m0, s63, 130272
    s_nop 0
    buffer_load_dwordx4 v14, s[32:35], s58 offen lds
    s_waitcnt vmcnt(2)
    ds_read_u16_d16_hi v192, v15 offset:3072
    ds_read_u16_d16_hi v193, v15 offset:3074
    ds_read_u16_d16_hi v194, v15 offset:3200
    ds_read_u16_d16_hi v195, v15 offset:3202
    ds_read_u16_d16_hi v196, v15 offset:3328
    ds_read_u16_d16_hi v197, v15 offset:3330
    ds_read_u16_d16_hi v198, v15 offset:3456
    ds_read_u16_d16_hi v199, v15 offset:3458
    ds_read_u16_d16_hi v200, v15 offset:3584
    ds_read_u16_d16_hi v201, v15 offset:3586
    ds_read_u16_d16_hi v202, v15 offset:3712
    ds_read_u16_d16_hi v203, v15 offset:3714
    ds_read_u16_d16_hi v204, v15 offset:3840
    ds_read_u16_d16_hi v205, v15 offset:3842
    ds_read_u16_d16_hi v206, v15 offset:3968
    ds_read_u16_d16_hi v207, v15 offset:3970
    s_setprio 3
    s_waitcnt lgkmcnt(0)
    v_pk_mul_f32 v[16:17], v[160:161], v[190:191]
    v_pk_mul_f32 v[18:19], v[162:163], v[190:191]
    v_pk_mul_f32 v[20:21], v[164:165], v[190:191]
    v_pk_mul_f32 v[22:23], v[166:167], v[190:191]
    v_pk_mul_f32 v[24:25], v[168:169], v[190:191]
    v_pk_mul_f32 v[26:27], v[170:171], v[190:191]
    v_pk_mul_f32 v[28:29], v[172:173], v[190:191]
    v_pk_mul_f32 v[30:31], v[174:175], v[190:191]
    v_pk_fma_f32 v[16:17], v[162:163], v[188:189], v[16:17]
    v_pk_fma_f32 v[18:19], v[164:165], v[188:189], v[18:19]
    v_pk_fma_f32 v[20:21], v[166:167], v[188:189], v[20:21]
    v_pk_fma_f32 v[22:23], v[168:169], v[188:189], v[22:23]
    v_pk_fma_f32 v[24:25], v[170:171], v[188:189], v[24:25]
    v_pk_fma_f32 v[26:27], v[172:173], v[188:189], v[26:27]
    v_pk_fma_f32 v[28:29], v[174:175], v[188:189], v[28:29]
    v_pk_fma_f32 v[30:31], v[176:177], v[188:189], v[30:31]
    v_pk_fma_f32 v[16:17], v[164:165], v[186:187], v[16:17]
    v_pk_fma_f32 v[18:19], v[166:167], v[186:187], v[18:19]
    v_pk_fma_f32 v[20:21], v[168:169], v[186:187], v[20:21]
    v_pk_fma_f32 v[22:23], v[170:171], v[186:187], v[22:23]
    v_pk_fma_f32 v[24:25], v[172:173], v[186:187], v[24:25]
    v_pk_fma_f32 v[26:27], v[174:175], v[186:187], v[26:27]
    v_pk_fma_f32 v[28:29], v[176:177], v[186:187], v[28:29]
    v_pk_fma_f32 v[30:31], v[178:179], v[186:187], v[30:31]
    v_pk_fma_f32 v[16:17], v[166:167], v[184:185], v[16:17]
    v_pk_fma_f32 v[18:19], v[168:169], v[184:185], v[18:19]
    v_pk_fma_f32 v[20:21], v[170:171], v[184:185], v[20:21]
    v_pk_fma_f32 v[22:23], v[172:173], v[184:185], v[22:23]
    v_pk_fma_f32 v[24:25], v[174:175], v[184:185], v[24:25]
    v_pk_fma_f32 v[26:27], v[176:177], v[184:185], v[26:27]
    v_pk_fma_f32 v[28:29], v[178:179], v[184:185], v[28:29]
    v_pk_fma_f32 v[30:31], v[180:181], v[184:185], v[30:31]
    v_pk_mul_f32 v[16:17], v[16:17], v[192:193]
    v_pk_mul_f32 v[18:19], v[18:19], v[194:195]
    v_pk_mul_f32 v[20:21], v[20:21], v[196:197]
    v_pk_mul_f32 v[22:23], v[22:23], v[198:199]
    v_pk_mul_f32 v[24:25], v[24:25], v[200:201]
    v_pk_mul_f32 v[26:27], v[26:27], v[202:203]
    v_pk_mul_f32 v[28:29], v[28:29], v[204:205]
    v_pk_mul_f32 v[30:31], v[30:31], v[206:207]
    v_cvt_pk_bf16_f32 v160, v30, v28
    v_cvt_pk_bf16_f32 v161, v26, v24
    v_cvt_pk_bf16_f32 v162, v22, v20
    v_cvt_pk_bf16_f32 v163, v18, v16
    v_cvt_pk_bf16_f32 v164, v31, v29
    v_cvt_pk_bf16_f32 v165, v27, v25
    v_cvt_pk_bf16_f32 v166, v23, v21
    v_cvt_pk_bf16_f32 v167, v19, v17
    s_setprio 3
    ds_write_b128 v11, v[160:163] offset:8192
    ds_write_b128 v11, v[164:167] offset:12288
    s_lshl_b32 s57, s51, 18
    s_sub_u32 s58, 31, s52
    s_lshl_b32 s58, s58, 7
    s_add_u32 s60, s57, s58
    s_add_u32 s60, s60, 4194304
    s_add_u32 s58, s60, 0x1000
    s_waitcnt lgkmcnt(0)
    s_add_u32 s73, s73, 4
    s_mov_b64 exec, 1
    ds_add_u32 v2, v3
L_hb5:
    ds_read_b32 v6, v2
    s_waitcnt lgkmcnt(0)
    v_cmp_gt_u32 vcc, s73, v6
    s_cbranch_vccz L_hb5x
    s_sleep 4
    s_branch L_hb5
L_hb5x:
    s_mov_b64 exec, -1
    ds_read_b128 v[160:163], v12 offset:8192
    ds_read_b128 v[164:167], v12 offset:12288
    s_waitcnt lgkmcnt(1)
    buffer_store_dwordx4 v[160:163], v13, s[44:47], s60 offen sc1
    s_waitcnt lgkmcnt(0)
    buffer_store_dwordx4 v[164:167], v13, s[44:47], s58 offen sc1
    s_lshr_b32 s57, s52, 3
    s_mul_i32 s57, s57, 96
    s_lshl2_add_u32 s57, s52, s57
    s_lshl_b32 s60, s51, 9
    s_add_u32 s60, s60, 10485760
    s_add_u32 s57, s57, s60
    s_waitcnt vmcnt(0)
    s_add_u32 s73, s73, 4
    s_mov_b64 exec, 1
    ds_add_u32 v2, v3
L_hb6:
    ds_read_b32 v6, v2
    s_waitcnt lgkmcnt(0)
    v_cmp_gt_u32 vcc, s73, v6
    s_cbranch_vccz L_hb6x
    s_sleep 4
    s_branch L_hb6
L_hb6x:
    s_mov_b64 exec, -1
    s_cmp_lg_u32 s48, 4
    s_cbranch_scc1 L_ow7
    s_mov_b64 exec, 0x1
    buffer_store_dword v52, v51, s[44:47], s57 offen sc1
    s_mov_b64 exec, -1
L_ow7:
    s_add_u32 m0, s68, 5120
    s_nop 0
    buffer_load_dwordx4 v8, s[16:19], s56 offen lds
    s_add_u32 m0, s68, 6144
    s_nop 0
    buffer_load_dwordx4 v8, s[16:19], s59 offen lds
    ds_read_b128 v[208:211], v32 offset:13534
    ds_read_b128 v[212:215], v32 offset:13532
    ds_read_b128 v[216:219], v32 offset:13530
    ds_read_b128 v[220:223], v32 offset:31582
    ds_read_b128 v[224:227], v32 offset:31580
    ds_read_b128 v[228:231], v32 offset:31578
    s_waitcnt lgkmcnt(5)
    ds_write_b128 v32, v[208:211] offset:9024
    s_waitcnt lgkmcnt(5)
    ds_write_b128 v32, v[212:215] offset:4512
    s_waitcnt lgkmcnt(5)
    ds_write_b128 v32, v[216:219]
    s_waitcnt lgkmcnt(5)
    ds_write_b128 v32, v[220:223] offset:27072
    s_waitcnt lgkmcnt(5)
    ds_write_b128 v32, v[224:227] offset:22560
    s_waitcnt lgkmcnt(5)
    ds_write_b128 v32, v[228:231] offset:18048
    s_lshr_b32 s58, s63, 3
    s_add_u32 s60, s60, s58
    s_xor_b32 s58, s63, 0xc00
    s_add_u32 s59, s66, s58
    s_add_u32 s59, s59, 4194304
    s_add_u32 m0, s58, 134400
    s_waitcnt vmcnt(0)
    ds_read_b32 v56, v15 offset:5120
    ds_read_b32 v57, v15 offset:5248
    ds_read_b32 v58, v15 offset:5376
    ds_read_b32 v59, v15 offset:5504
    ds_read_b32 v60, v15 offset:5632
    ds_read_b32 v61, v15 offset:5760
    ds_read_b32 v62, v15 offset:5888
    ds_read_b32 v63, v15 offset:6016
    s_mov_b32 s67, 0
L_spoll8:
    s_load_dwordx8 s[4:11], s[44:45], s60 glc
    s_add_u32 s67, s67, 1
    s_cmp_ge_u32 s67, 16384
    s_waitcnt lgkmcnt(0)
    s_cbranch_scc1 L_spollok9
    s_xor_b64 s[4:5], s[4:5], s[70:71]
    s_xor_b64 s[6:7], s[6:7], s[70:71]
    s_xor_b64 s[8:9], s[8:9], s[70:71]
    s_xor_b64 s[10:11], s[10:11], s[70:71]
    s_or_b64 s[4:5], s[4:5], s[6:7]
    s_or_b64 s[8:9], s[8:9], s[10:11]
    s_or_b64 s[4:5], s[4:5], s[8:9]
    s_cbranch_scc0 L_spollok9
    s_sleep 8
    s_branch L_spoll8
L_spollok9:
    buffer_load_dwordx4 v35, s[44:47], s59 offen sc1 lds
    s_addk_i32 m0, 4224
    s_add_u32 s59, s59, 0x1000
    buffer_load_dwordx4 v35, s[44:47], s59 offen sc1 lds
    s_lshl_b32 s57, s3, 12
    s_add_u32 s66, s66, s57
    s_mov_b32 s65, 0
    s_lshr_b32 s57, s52, 2
    s_mul_i32 s57, s57, 12288
    s_waitcnt vmcnt(0) lgkmcnt(0)
    s_add_u32 s73, s73, 4
    s_mov_b64 exec, 1
    ds_add_u32 v2, v3
L_hb10:
    ds_read_b32 v6, v2
    s_waitcnt lgkmcnt(0)
    v_cmp_gt_u32 vcc, s73, v6
    s_cbranch_vccz L_hb10x
    s_sleep 4
    s_branch L_hb10
L_hb10x:
    s_mov_b64 exec, -1
    s_setprio 0
L_conv:
    ds_read_b64 v[96:97], v34 offset:3584
    ds_read_b64 v[98:99], v34 offset:3592
    ds_read_b64 v[100:101], v34 offset:3072
    ds_read_b64 v[102:103], v34 offset:3080
    ds_read_b64 v[104:105], v34 offset:2560
    ds_read_b64 v[106:107], v34 offset:2568
    ds_read_b64 v[108:109], v34 offset:2048
    ds_read_b64 v[110:111], v34 offset:2056
    ds_read_b64 v[112:113], v34 offset:1536
    ds_read_b64 v[114:115], v34 offset:1544
    ds_read_b64 v[116:117], v34 offset:1024
    ds_read_b64 v[118:119], v34 offset:1032
    ds_read_b64 v[120:121], v34 offset:512
    ds_read_b64 v[122:123], v34 offset:520
    ds_read_b64 v[124:125], v34
    ds_read_b64 v[126:127], v34 offset:8
    ds_read_b128 v[128:131], v33
    s_add_u32 m0, s63, s57
    s_lshl_b32 s61, s57, 2
    buffer_load_dwordx4 v36, s[12:15], s61 offen lds
    s_add_u32 s57, s57, 0x1000
    s_cmp_eq_u32 s57, 98304
    s_cselect_b32 s57, 0, s57
    s_waitcnt lgkmcnt(0)
    v_mfma_f32_16x16x32_bf16 v[64:67], v[128:131], v[96:99], v[64:67]
    v_mfma_f32_16x16x32_bf16 v[68:71], v[128:131], v[100:103], v[68:71]
    v_mfma_f32_16x16x32_bf16 v[72:75], v[128:131], v[104:107], v[72:75]
    v_mfma_f32_16x16x32_bf16 v[76:79], v[128:131], v[108:111], v[76:79]
    v_mfma_f32_16x16x32_bf16 v[80:83], v[128:131], v[112:115], v[80:83]
    v_mfma_f32_16x16x32_bf16 v[84:87], v[128:131], v[116:119], v[84:87]
    v_mfma_f32_16x16x32_bf16 v[88:91], v[128:131], v[120:123], v[88:91]
    v_mfma_f32_16x16x32_bf16 v[92:95], v[128:131], v[124:127], v[92:95]
    ds_read_b128 v[128:131], v33 offset:512
    s_add_u32 m0, s63, s57
    s_lshl_b32 s61, s57, 2
    buffer_load_dwordx4 v36, s[12:15], s61 offen lds
    s_add_u32 s57, s57, 0x1000
    s_cmp_eq_u32 s57, 98304
    s_cselect_b32 s57, 0, s57
    s_waitcnt lgkmcnt(0)
    v_mfma_f32_16x16x32_bf16 v[68:71], v[128:131], v[96:99], v[68:71]
    v_mfma_f32_16x16x32_bf16 v[72:75], v[128:131], v[100:103], v[72:75]
    v_mfma_f32_16x16x32_bf16 v[76:79], v[128:131], v[104:107], v[76:79]
    v_mfma_f32_16x16x32_bf16 v[80:83], v[128:131], v[108:111], v[80:83]
    v_mfma_f32_16x16x32_bf16 v[84:87], v[128:131], v[112:115], v[84:87]
    v_mfma_f32_16x16x32_bf16 v[88:91], v[128:131], v[116:119], v[88:91]
    v_mfma_f32_16x16x32_bf16 v[92:95], v[128:131], v[120:123], v[92:95]
    ds_read_b128 v[128:131], v33 offset:1024
    s_add_u32 m0, s63, s57
    s_lshl_b32 s61, s57, 2
    buffer_load_dwordx4 v36, s[12:15], s61 offen lds
    s_add_u32 s57, s57, 0x1000
    s_cmp_eq_u32 s57, 98304
    s_cselect_b32 s57, 0, s57
    s_waitcnt lgkmcnt(0)
    v_mfma_f32_16x16x32_bf16 v[72:75], v[128:131], v[96:99], v[72:75]
    v_mfma_f32_16x16x32_bf16 v[76:79], v[128:131], v[100:103], v[76:79]
    v_mfma_f32_16x16x32_bf16 v[80:83], v[128:131], v[104:107], v[80:83]
    v_mfma_f32_16x16x32_bf16 v[84:87], v[128:131], v[108:111], v[84:87]
    v_mfma_f32_16x16x32_bf16 v[88:91], v[128:131], v[112:115], v[88:91]
    v_mfma_f32_16x16x32_bf16 v[92:95], v[128:131], v[116:119], v[92:95]
    ds_read_b128 v[128:131], v33 offset:1536
    s_add_u32 m0, s63, s57
    s_lshl_b32 s61, s57, 2
    buffer_load_dwordx4 v36, s[12:15], s61 offen lds
    s_add_u32 s57, s57, 0x1000
    s_cmp_eq_u32 s57, 98304
    s_cselect_b32 s57, 0, s57
    s_waitcnt lgkmcnt(0)
    v_mfma_f32_16x16x32_bf16 v[76:79], v[128:131], v[96:99], v[76:79]
    v_mfma_f32_16x16x32_bf16 v[80:83], v[128:131], v[100:103], v[80:83]
    v_mfma_f32_16x16x32_bf16 v[84:87], v[128:131], v[104:107], v[84:87]
    v_mfma_f32_16x16x32_bf16 v[88:91], v[128:131], v[108:111], v[88:91]
    v_mfma_f32_16x16x32_bf16 v[92:95], v[128:131], v[112:115], v[92:95]
    ds_read_b128 v[128:131], v33 offset:2048
    s_add_u32 m0, s63, s57
    s_lshl_b32 s61, s57, 2
    buffer_load_dwordx4 v36, s[12:15], s61 offen lds
    s_add_u32 s57, s57, 0x1000
    s_cmp_eq_u32 s57, 98304
    s_cselect_b32 s57, 0, s57
    s_waitcnt lgkmcnt(0)
    v_mfma_f32_16x16x32_bf16 v[80:83], v[128:131], v[96:99], v[80:83]
    v_mfma_f32_16x16x32_bf16 v[84:87], v[128:131], v[100:103], v[84:87]
    v_mfma_f32_16x16x32_bf16 v[88:91], v[128:131], v[104:107], v[88:91]
    v_mfma_f32_16x16x32_bf16 v[92:95], v[128:131], v[108:111], v[92:95]
    ds_read_b128 v[128:131], v33 offset:2560
    s_add_u32 m0, s63, s57
    s_lshl_b32 s61, s57, 2
    buffer_load_dwordx4 v36, s[12:15], s61 offen lds
    s_add_u32 s57, s57, 0x1000
    s_cmp_eq_u32 s57, 98304
    s_cselect_b32 s57, 0, s57
    s_waitcnt lgkmcnt(0)
    v_mfma_f32_16x16x32_bf16 v[84:87], v[128:131], v[96:99], v[84:87]
    v_mfma_f32_16x16x32_bf16 v[88:91], v[128:131], v[100:103], v[88:91]
    v_mfma_f32_16x16x32_bf16 v[92:95], v[128:131], v[104:107], v[92:95]
    ds_read_b128 v[128:131], v33 offset:3072
    s_waitcnt lgkmcnt(0)
    v_mfma_f32_16x16x32_bf16 v[88:91], v[128:131], v[96:99], v[88:91]
    v_mfma_f32_16x16x32_bf16 v[92:95], v[128:131], v[100:103], v[92:95]
    ds_read_b128 v[128:131], v33 offset:3584
    s_waitcnt lgkmcnt(0)
    v_mfma_f32_16x16x32_bf16 v[92:95], v[128:131], v[96:99], v[92:95]
    s_setprio 3
    v_add_u32 v34, 64, v34
    v_add_u32 v33, 64, v33
    s_setprio 0
    s_add_u32 s65, s65, 1
    s_cmp_lg_u32 s65, 4
    s_cbranch_scc1 L_conv
    s_setprio 3
    s_lshl_b32 s57, s69, 11
    s_add_u32 s66, s66, s57
    s_add_u32 s66, s66, 6291456
    s_cmp_lg_u32 s69, 0
    s_cbranch_scc1 L_red1
    ds_write_b128 v44, v[80:83]
    ds_write_b128 v44, v[84:87] offset:1024
    ds_write_b128 v44, v[88:91] offset:2048
    ds_write_b128 v44, v[92:95] offset:3072
    s_waitcnt vmcnt(0) lgkmcnt(0)
    s_add_u32 s73, s73, 4
    s_mov_b64 exec, 1
    ds_add_u32 v2, v3
L_hb11:
    ds_read_b32 v6, v2
    s_waitcnt lgkmcnt(0)
    v_cmp_gt_u32 vcc, s73, v6
    s_cbranch_vccz L_hb11x
    s_sleep 4
    s_branch L_hb11
L_hb11x:
    s_mov_b64 exec, -1
    ds_read_b128 v[96:99], v45
    ds_read_b128 v[100:103], v45 offset:1024
    ds_read_b128 v[104:107], v45 offset:2048
    ds_read_b128 v[108:111], v45 offset:3072
    s_setprio 3
    s_waitcnt lgkmcnt(0)
    v_pk_add_f32 v[96:97], v[96:97], v[64:65]
    v_pk_add_f32 v[98:99], v[98:99], v[66:67]
    v_pk_add_f32 v[100:101], v[100:101], v[68:69]
    v_pk_add_f32 v[102:103], v[102:103], v[70:71]
    v_pk_add_f32 v[104:105], v[104:105], v[72:73]
    v_pk_add_f32 v[106:107], v[106:107], v[74:75]
    v_pk_add_f32 v[108:109], v[108:109], v[76:77]
    v_pk_add_f32 v[110:111], v[110:111], v[78:79]
    s_branch L_red2
L_red1:
    ds_write_b128 v44, v[64:67]
    ds_write_b128 v44, v[68:71] offset:1024
    ds_write_b128 v44, v[72:75] offset:2048
    ds_write_b128 v44, v[76:79] offset:3072
    s_waitcnt vmcnt(0) lgkmcnt(0)
    s_add_u32 s73, s73, 4
    s_mov_b64 exec, 1
    ds_add_u32 v2, v3
L_hb12:
    ds_read_b32 v6, v2
    s_waitcnt lgkmcnt(0)
    v_cmp_gt_u32 vcc, s73, v6
    s_cbranch_vccz L_hb12x
    s_sleep 4
    s_branch L_hb12
L_hb12x:
    s_mov_b64 exec, -1
    ds_read_b128 v[96:99], v45
    ds_read_b128 v[100:103], v45 offset:1024
    ds_read_b128 v[104:107], v45 offset:2048
    ds_read_b128 v[108:111], v45 offset:3072
    s_setprio 3
    s_waitcnt lgkmcnt(0)
    v_pk_add_f32 v[96:97], v[96:97], v[80:81]
    v_pk_add_f32 v[98:99], v[98:99], v[82:83]
    v_pk_add_f32 v[100:101], v[100:101], v[84:85]
    v_pk_add_f32 v[102:103], v[102:103], v[86:87]
    v_pk_add_f32 v[104:105], v[104:105], v[88:89]
    v_pk_add_f32 v[106:107], v[106:107], v[90:91]
    v_pk_add_f32 v[108:109], v[108:109], v[92:93]
    v_pk_add_f32 v[110:111], v[110:111], v[94:95]
L_red2:
    v_cvt_pk_bf16_f32 v64, v96, v97
    v_cvt_pk_bf16_f32 v65, v98, v99
    v_cvt_pk_bf16_f32 v66, v100, v101
    v_cvt_pk_bf16_f32 v67, v102, v103
    v_cvt_pk_bf16_f32 v68, v104, v105
    v_cvt_pk_bf16_f32 v69, v106, v107
    v_cvt_pk_bf16_f32 v70, v108, v109
    v_cvt_pk_bf16_f32 v71, v110, v111
    s_setprio 3
    buffer_store_dwordx2 v[64:65], v46, s[44:47], s66 offen sc1
    buffer_store_dwordx2 v[66:67], v46, s[44:47], s66 offen offset:512 sc1
    buffer_store_dwordx2 v[68:69], v46, s[44:47], s66 offen offset:1024 sc1
    buffer_store_dwordx2 v[70:71], v46, s[44:47], s66 offen offset:1536 sc1
    ds_read_b64_tr_b16 v[128:129], v38
    ds_read_b64_tr_b16 v[130:131], v38 offset:2048
    ds_read_b64_tr_b16 v[132:133], v38 offset:4096
    ds_read_b64_tr_b16 v[134:135], v38 offset:6144
    ds_read_b64_tr_b16 v[136:137], v38 offset:8192
    ds_read_b64_tr_b16 v[138:139], v38 offset:10240
    ds_read_b64_tr_b16 v[140:141], v38 offset:12288
    ds_read_b64_tr_b16 v[142:143], v38 offset:14336
    ds_read_b64_tr_b16 v[144:145], v38 offset:16384
    ds_read_b64_tr_b16 v[146:147], v38 offset:18432
    ds_read_b64_tr_b16 v[148:149], v38 offset:20480
    ds_read_b64_tr_b16 v[150:151], v38 offset:22528
    ds_read_b64_tr_b16 v[152:153], v38 offset:24576
    ds_read_b64_tr_b16 v[154:155], v38 offset:26624
    ds_read_b64_tr_b16 v[156:157], v38 offset:28672
    ds_read_b64_tr_b16 v[158:159], v38 offset:30720
    s_lshr_b32 s57, s52, 3
    s_mul_i32 s57, s57, 96
    s_lshl2_add_u32 s57, s52, s57
    s_lshl_b32 s60, s51, 9
    s_add_u32 s60, s60, 10551296
    s_add_u32 s57, s57, s60
    s_waitcnt vmcnt(0)
    s_mov_b64 exec, 1
    ds_add_rtn_u32 v7, v2, v3 offset:12
    s_waitcnt lgkmcnt(0)
    v_cmp_ne_u32 vcc, 3, v7
    s_cbranch_vccnz L_arr13
    buffer_store_dword v52, v51, s[44:47], s57 offen sc1
L_arr13:
    s_mov_b64 exec, -1
    s_lshr_b32 s57, s52, 2
    s_mul_i32 s57, s57, 4096
    s_add_u32 s57, s57, 98304
    s_mov_b32 s58, 0
L_wo:
    s_add_u32 m0, s63, s57
    s_lshl_b32 s61, s57, 2
    buffer_load_dwordx4 v36, s[12:15], s61 offen lds
    s_add_u32 s57, s57, 0x1000
    s_cmp_eq_u32 s57, 131072
    s_cselect_b32 s57, 98304, s57
    s_add_u32 s58, s58, 1
    s_cmp_lg_u32 s58, 8
    s_waitcnt vmcnt(3)
    s_cbranch_scc1 L_wo
    s_lshr_b32 s58, s63, 3
    s_add_u32 s60, s60, s58
    s_mov_b32 s67, 0
L_spoll14:
    s_load_dwordx8 s[4:11], s[44:45], s60 glc
    s_add_u32 s67, s67, 1
    s_cmp_ge_u32 s67, 16384
    s_waitcnt lgkmcnt(0)
    s_cbranch_scc1 L_spollok15
    s_xor_b64 s[4:5], s[4:5], s[70:71]
    s_xor_b64 s[6:7], s[6:7], s[70:71]
    s_xor_b64 s[8:9], s[8:9], s[70:71]
    s_xor_b64 s[10:11], s[10:11], s[70:71]
    s_or_b64 s[4:5], s[4:5], s[6:7]
    s_or_b64 s[8:9], s[8:9], s[10:11]
    s_or_b64 s[4:5], s[4:5], s[8:9]
    s_cbranch_scc0 L_spollok15
    s_sleep 8
    s_branch L_spoll14
L_spollok15:
    s_lshl_b32 s57, s51, 18
    s_lshl_b32 s58, s52, 7
    s_add_u32 s57, s57, s58
    s_add_u32 m0, s63, 131072
    s_add_u32 s57, s57, 6291456
    buffer_load_dwordx4 v37, s[44:47], s57 offen sc1 lds
    s_add_u32 m0, s63, 135168
    s_add_u32 s57, s57, 0x1000
    buffer_load_dwordx4 v37, s[44:47], s57 offen sc1 lds
    s_lshr_b32 s57, s52, 2
    s_lshl3_add_u32 s61, s49, s57
    s_lshl_b32 s61, s61, 16
    s_and_b32 s58, s52, 3
    s_lshl2_add_u32 s58, s58, s72
    s_lshl_b32 s58, s58, 6
    s_add_u32 s61, s61, s58
    s_lshl_b32 s56, s52, 17
    s_lshl_b32 s59, s51, 7
    s_add_u32 s56, s56, s59
    s_mov_b32 s65, 0
    s_waitcnt vmcnt(0)
    s_barrier
    ds_read_b128 v[96:99], v40
    ds_read_b128 v[100:103], v40 offset:4096
    ds_read_b64_tr_b16 v[160:161], v38 offset:32768
    v_lshlrev_b32 v64, 16, v56
    ds_read_b64_tr_b16 v[162:163], v38 offset:34816
    v_and_b32 v65, s55, v56
    ds_read_b64_tr_b16 v[164:165], v38 offset:36864
    v_lshlrev_b32 v66, 16, v57
    ds_read_b64_tr_b16 v[166:167], v38 offset:38912
    v_and_b32 v67, s55, v57
    ds_read_b64_tr_b16 v[168:169], v38 offset:40960
    v_lshlrev_b32 v68, 16, v58
    ds_read_b64_tr_b16 v[170:171], v38 offset:43008
    v_and_b32 v69, s55, v58
    ds_read_b64_tr_b16 v[172:173], v38 offset:45056
    v_lshlrev_b32 v70, 16, v59
    ds_read_b64_tr_b16 v[174:175], v38 offset:47104
    v_and_b32 v71, s55, v59
    ds_read_b64_tr_b16 v[176:177], v38 offset:49152
    v_lshlrev_b32 v72, 16, v60
    ds_read_b64_tr_b16 v[178:179], v38 offset:51200
    v_and_b32 v73, s55, v60
    ds_read_b64_tr_b16 v[180:181], v38 offset:53248
    v_lshlrev_b32 v74, 16, v61
    ds_read_b64_tr_b16 v[182:183], v38 offset:55296
    v_and_b32 v75, s55, v61
    ds_read_b64_tr_b16 v[184:185], v38 offset:57344
    v_lshlrev_b32 v76, 16, v62
    ds_read_b64_tr_b16 v[186:187], v38 offset:59392
    v_and_b32 v77, s55, v62
    ds_read_b64_tr_b16 v[188:189], v38 offset:61440
    v_lshlrev_b32 v78, 16, v63
    ds_read_b64_tr_b16 v[190:191], v38 offset:63488
    v_and_b32 v79, s55, v63
    ds_read_b64_tr_b16 v[192:193], v39
    s_waitcnt lgkmcnt(15)
    ds_read_b64_tr_b16 v[194:195], v39 offset:2048
    v_lshlrev_b32 v80, 16, v96
    ds_read_b64_tr_b16 v[196:197], v39 offset:4096
    v_and_b32 v82, s55, v96
    ds_read_b64_tr_b16 v[198:199], v39 offset:6144
    v_lshlrev_b32 v84, 16, v97
    ds_read_b64_tr_b16 v[200:201], v39 offset:8192
    v_and_b32 v86, s55, v97
    ds_read_b64_tr_b16 v[202:203], v39 offset:10240
    v_lshlrev_b32 v88, 16, v98
    ds_read_b64_tr_b16 v[204:205], v39 offset:12288
    v_and_b32 v90, s55, v98
    ds_read_b64_tr_b16 v[206:207], v39 offset:14336
    v_lshlrev_b32 v92, 16, v99
    ds_read_b64_tr_b16 v[208:209], v39 offset:16384
    v_and_b32 v94, s55, v99
    ds_read_b64_tr_b16 v[210:211], v39 offset:18432
    v_lshlrev_b32 v81, 16, v100
    ds_read_b64_tr_b16 v[212:213], v39 offset:20480
    v_and_b32 v83, s55, v100
    ds_read_b64_tr_b16 v[214:215], v39 offset:22528
    v_lshlrev_b32 v85, 16, v101
    ds_read_b64_tr_b16 v[216:217], v39 offset:24576
    v_and_b32 v87, s55, v101
    ds_read_b64_tr_b16 v[218:219], v39 offset:26624
    v_lshlrev_b32 v89, 16, v102
    ds_read_b64_tr_b16 v[220:221], v39 offset:28672
    v_and_b32 v91, s55, v102
    ds_read_b64_tr_b16 v[222:223], v39 offset:30720
    v_lshlrev_b32 v93, 16, v103
    ds_read_b64_tr_b16 v[224:225], v39 offset:32768
    v_and_b32 v95, s55, v103
    ds_read_b64_tr_b16 v[226:227], v39 offset:34816
    v_pk_fma_f32 v[80:81], v[16:17], v[48:49], v[80:81]
    ds_read_b64_tr_b16 v[228:229], v39 offset:36864
    v_pk_fma_f32 v[82:83], v[18:19], v[48:49], v[82:83]
    ds_read_b64_tr_b16 v[230:231], v39 offset:38912
    v_pk_fma_f32 v[84:85], v[20:21], v[48:49], v[84:85]
    ds_read_b64_tr_b16 v[232:233], v39 offset:40960
    v_pk_fma_f32 v[86:87], v[22:23], v[48:49], v[86:87]
    ds_read_b64_tr_b16 v[234:235], v39 offset:43008
    v_pk_fma_f32 v[88:89], v[24:25], v[48:49], v[88:89]
    ds_read_b64_tr_b16 v[236:237], v39 offset:45056
    v_pk_fma_f32 v[90:91], v[26:27], v[48:49], v[90:91]
    ds_read_b64_tr_b16 v[238:239], v39 offset:47104
    v_pk_fma_f32 v[92:93], v[28:29], v[48:49], v[92:93]
    ds_read_b64_tr_b16 v[240:241], v39 offset:49152
    v_pk_fma_f32 v[94:95], v[30:31], v[48:49], v[94:95]
    ds_read_b64_tr_b16 v[242:243], v39 offset:51200
    v_pk_mul_f32 v[80:81], v[80:81], v[64:65]
    ds_read_b64_tr_b16 v[244:245], v39 offset:53248
    v_pk_mul_f32 v[82:83], v[82:83], v[66:67]
    ds_read_b64_tr_b16 v[246:247], v39 offset:55296
    v_pk_mul_f32 v[84:85], v[84:85], v[68:69]
    ds_read_b64_tr_b16 v[248:249], v39 offset:57344
    v_pk_mul_f32 v[86:87], v[86:87], v[70:71]
    ds_read_b64_tr_b16 v[250:251], v39 offset:59392
    v_pk_mul_f32 v[88:89], v[88:89], v[72:73]
    ds_read_b64_tr_b16 v[252:253], v39 offset:61440
    v_pk_mul_f32 v[90:91], v[90:91], v[74:75]
    ds_read_b64_tr_b16 v[254:255], v39 offset:63488
    v_pk_mul_f32 v[92:93], v[92:93], v[76:77]
    v_pk_mul_f32 v[94:95], v[94:95], v[78:79]
    v_cvt_pk_bf16_f32 v56, v80, v81
    v_cvt_pk_bf16_f32 v57, v82, v83
    v_cvt_pk_bf16_f32 v58, v84, v85
    v_cvt_pk_bf16_f32 v59, v86, v87
    v_cvt_pk_bf16_f32 v60, v88, v89
    v_cvt_pk_bf16_f32 v61, v90, v91
    v_cvt_pk_bf16_f32 v62, v92, v93
    v_cvt_pk_bf16_f32 v63, v94, v95
    v_mov_b32 v8, v35
    v_mov_b32 v9, v41
    v_mov_b32 v10, v43
    v_xor_b32 v4, 16, v54
L_pw:
    ds_read_b32 v6, v2 offset:4
    s_waitcnt lgkmcnt(0)
    v_readfirstlane_b32 s58, v6
    s_andn2_b32 s58, s58, s65
    s_cbranch_scc0 L_pw
    s_or_b32 s65, s65, s58
    s_bitcmp1_b32 s58, 0
    s_cbranch_scc0 L_pq16
    ds_read_b128 v[64:67], v8
    ds_read_b128 v[68:71], v8 offset:1024
    ds_read_b128 v[72:75], v8 offset:2048
    ds_read_b128 v[76:79], v8 offset:3072
    ds_read_b128 v[80:83], v8 offset:4096
    ds_read_b128 v[84:87], v8 offset:5120
    ds_read_b128 v[88:91], v8 offset:6144
    ds_read_b128 v[92:95], v8 offset:7168
    s_add_u32 s57, s56, 0
    s_waitcnt lgkmcnt(7)
    v_mfma_f32_32x32x16_bf16 v[16:31], v[128:131], v[64:67], 0
    s_waitcnt lgkmcnt(6)
    v_mfma_f32_32x32x16_bf16 v[16:31], v[132:135], v[68:71], v[16:31]
    buffer_store_dword v56, v9, s[40:43], s57 offen offset:1024 sc1
    s_waitcnt lgkmcnt(5)
    v_mfma_f32_32x32x16_bf16 v[16:31], v[136:139], v[72:75], v[16:31]
    s_waitcnt lgkmcnt(4)
    v_mfma_f32_32x32x16_bf16 v[16:31], v[140:143], v[76:79], v[16:31]
    buffer_store_dword v57, v9, s[40:43], s57 offen offset:3072 sc1
    s_waitcnt lgkmcnt(3)
    v_mfma_f32_32x32x16_bf16 v[16:31], v[144:147], v[80:83], v[16:31]
    s_waitcnt lgkmcnt(2)
    v_mfma_f32_32x32x16_bf16 v[16:31], v[148:151], v[84:87], v[16:31]
    s_waitcnt lgkmcnt(1)
    v_mfma_f32_32x32x16_bf16 v[16:31], v[152:155], v[88:91], v[16:31]
    s_waitcnt lgkmcnt(0)
    v_mfma_f32_32x32x16_bf16 v[16:31], v[156:159], v[92:95], v[16:31]
L_pq16:
    s_bitcmp1_b32 s58, 1
    s_cbranch_scc0 L_pq17
    ds_read_b128 v[64:67], v8 offset:8192
    ds_read_b128 v[68:71], v8 offset:9216
    ds_read_b128 v[72:75], v8 offset:10240
    ds_read_b128 v[76:79], v8 offset:11264
    ds_read_b128 v[80:83], v8 offset:12288
    ds_read_b128 v[84:87], v8 offset:13312
    ds_read_b128 v[88:91], v8 offset:14336
    ds_read_b128 v[92:95], v8 offset:15360
    s_add_u32 s57, s56, 4096
    s_waitcnt lgkmcnt(7)
    v_mfma_f32_32x32x16_bf16 v[32:47], v[160:163], v[64:67], 0
    s_waitcnt lgkmcnt(6)
    v_mfma_f32_32x32x16_bf16 v[32:47], v[164:167], v[68:71], v[32:47]
    buffer_store_dword v58, v9, s[40:43], s57 offen offset:1024 sc1
    s_waitcnt lgkmcnt(5)
    v_mfma_f32_32x32x16_bf16 v[32:47], v[168:171], v[72:75], v[32:47]
    s_waitcnt lgkmcnt(4)
    v_mfma_f32_32x32x16_bf16 v[32:47], v[172:175], v[76:79], v[32:47]
    buffer_store_dword v59, v9, s[40:43], s57 offen offset:3072 sc1
    s_waitcnt lgkmcnt(3)
    v_mfma_f32_32x32x16_bf16 v[32:47], v[176:179], v[80:83], v[32:47]
    s_waitcnt lgkmcnt(2)
    v_mfma_f32_32x32x16_bf16 v[32:47], v[180:183], v[84:87], v[32:47]
    s_waitcnt lgkmcnt(1)
    v_mfma_f32_32x32x16_bf16 v[32:47], v[184:187], v[88:91], v[32:47]
    s_waitcnt lgkmcnt(0)
    v_mfma_f32_32x32x16_bf16 v[32:47], v[188:191], v[92:95], v[32:47]
L_pq17:
    s_bitcmp1_b32 s58, 2
    s_cbranch_scc0 L_pq18
    ds_read_b128 v[64:67], v8 offset:16384
    ds_read_b128 v[68:71], v8 offset:17408
    ds_read_b128 v[72:75], v8 offset:18432
    ds_read_b128 v[76:79], v8 offset:19456
    ds_read_b128 v[80:83], v8 offset:20480
    ds_read_b128 v[84:87], v8 offset:21504
    ds_read_b128 v[88:91], v8 offset:22528
    ds_read_b128 v[92:95], v8 offset:23552
    s_add_u32 s57, s56, 8192
    s_waitcnt lgkmcnt(7)
    v_mfma_f32_32x32x16_bf16 v[96:111], v[192:195], v[64:67], 0
    s_waitcnt lgkmcnt(6)
    v_mfma_f32_32x32x16_bf16 v[96:111], v[196:199], v[68:71], v[96:111]
    buffer_store_dword v60, v9, s[40:43], s57 offen offset:1024 sc1
    s_waitcnt lgkmcnt(5)
    v_mfma_f32_32x32x16_bf16 v[96:111], v[200:203], v[72:75], v[96:111]
    s_waitcnt lgkmcnt(4)
    v_mfma_f32_32x32x16_bf16 v[96:111], v[204:207], v[76:79], v[96:111]
    buffer_store_dword v61, v9, s[40:43], s57 offen offset:3072 sc1
    s_waitcnt lgkmcnt(3)
    v_mfma_f32_32x32x16_bf16 v[96:111], v[208:211], v[80:83], v[96:111]
    s_waitcnt lgkmcnt(2)
    v_mfma_f32_32x32x16_bf16 v[96:111], v[212:215], v[84:87], v[96:111]
    s_waitcnt lgkmcnt(1)
    v_mfma_f32_32x32x16_bf16 v[96:111], v[216:219], v[88:91], v[96:111]
    s_waitcnt lgkmcnt(0)
    v_mfma_f32_32x32x16_bf16 v[96:111], v[220:223], v[92:95], v[96:111]
L_pq18:
    s_bitcmp1_b32 s58, 3
    s_cbranch_scc0 L_pq19
    ds_read_b128 v[64:67], v8 offset:24576
    ds_read_b128 v[68:71], v8 offset:25600
    ds_read_b128 v[72:75], v8 offset:26624
    ds_read_b128 v[76:79], v8 offset:27648
    ds_read_b128 v[80:83], v8 offset:28672
    ds_read_b128 v[84:87], v8 offset:29696
    ds_read_b128 v[88:91], v8 offset:30720
    ds_read_b128 v[92:95], v8 offset:31744
    s_add_u32 s57, s56, 12288
    s_waitcnt lgkmcnt(7)
    v_mfma_f32_32x32x16_bf16 v[112:127], v[224:227], v[64:67], 0
    s_waitcnt lgkmcnt(6)
    v_mfma_f32_32x32x16_bf16 v[112:127], v[228:231], v[68:71], v[112:127]
    buffer_store_dword v62, v9, s[40:43], s57 offen offset:1024 sc1
    s_waitcnt lgkmcnt(5)
    v_mfma_f32_32x32x16_bf16 v[112:127], v[232:235], v[72:75], v[112:127]
    s_waitcnt lgkmcnt(4)
    v_mfma_f32_32x32x16_bf16 v[112:127], v[236:239], v[76:79], v[112:127]
    buffer_store_dword v63, v9, s[40:43], s57 offen offset:3072 sc1
    s_waitcnt lgkmcnt(3)
    v_mfma_f32_32x32x16_bf16 v[112:127], v[240:243], v[80:83], v[112:127]
    s_waitcnt lgkmcnt(2)
    v_mfma_f32_32x32x16_bf16 v[112:127], v[244:247], v[84:87], v[112:127]
    s_waitcnt lgkmcnt(1)
    v_mfma_f32_32x32x16_bf16 v[112:127], v[248:251], v[88:91], v[112:127]
    s_waitcnt lgkmcnt(0)
    v_mfma_f32_32x32x16_bf16 v[112:127], v[252:255], v[92:95], v[112:127]
L_pq19:
    s_cmp_lg_u32 s65, 15
    s_cbranch_scc1 L_pw
    s_or_b32 s57, s2, s72
    s_cbranch_scc1 L_noep
    v_mov_b32 v6, 10616832
    s_mov_b64 exec, 1
    buffer_store_dword v52, v6, s[44:47], 0 offen sc1
    s_mov_b64 exec, -1
L_noep:
    s_nop 7
    v_pk_add_f32 v[16:17], v[16:17], v[32:33]
    v_pk_add_f32 v[96:97], v[96:97], v[112:113]
    v_pk_add_f32 v[18:19], v[18:19], v[34:35]
    v_pk_add_f32 v[98:99], v[98:99], v[114:115]
    v_pk_add_f32 v[20:21], v[20:21], v[36:37]
    v_pk_add_f32 v[100:101], v[100:101], v[116:117]
    v_pk_add_f32 v[22:23], v[22:23], v[38:39]
    v_pk_add_f32 v[102:103], v[102:103], v[118:119]
    v_pk_add_f32 v[16:17], v[16:17], v[96:97]
    v_pk_add_f32 v[18:19], v[18:19], v[98:99]
    v_pk_add_f32 v[20:21], v[20:21], v[100:101]
    v_pk_add_f32 v[22:23], v[22:23], v[102:103]
    v_cvt_pk_bf16_f32 v64, v16, v17
    v_cvt_pk_bf16_f32 v65, v18, v19
    v_cvt_pk_bf16_f32 v66, v20, v21
    v_cvt_pk_bf16_f32 v67, v22, v23
    ds_write_b128 v54, v[64:67]
    v_pk_add_f32 v[24:25], v[24:25], v[40:41]
    v_pk_add_f32 v[104:105], v[104:105], v[120:121]
    v_pk_add_f32 v[26:27], v[26:27], v[42:43]
    v_pk_add_f32 v[106:107], v[106:107], v[122:123]
    v_pk_add_f32 v[28:29], v[28:29], v[44:45]
    v_pk_add_f32 v[108:109], v[108:109], v[124:125]
    v_pk_add_f32 v[30:31], v[30:31], v[46:47]
    v_pk_add_f32 v[110:111], v[110:111], v[126:127]
    v_pk_add_f32 v[24:25], v[24:25], v[104:105]
    v_pk_add_f32 v[26:27], v[26:27], v[106:107]
    v_pk_add_f32 v[28:29], v[28:29], v[108:109]
    v_pk_add_f32 v[30:31], v[30:31], v[110:111]
    v_cvt_pk_bf16_f32 v68, v24, v25
    v_cvt_pk_bf16_f32 v69, v26, v27
    v_cvt_pk_bf16_f32 v70, v28, v29
    v_cvt_pk_bf16_f32 v71, v30, v31
    ds_write_b128 v4, v[68:71]
    ds_read_b128 v[72:75], v55
    ds_read_b128 v[76:79], v55 offset:1024
    s_add_u32 s57, s61, 0x8000
    s_waitcnt lgkmcnt(1)
    buffer_store_dwordx4 v[72:75], v10, s[40:43], s61 offen sc1
    s_waitcnt lgkmcnt(0)
    buffer_store_dwordx4 v[76:79], v10, s[40:43], s57 offen sc1
    s_endpgm
L_main:
    s_waitcnt lgkmcnt(0)
    v_and_b32 v1, 63, v0
    s_add_u32 s88, s44, 10616832
    s_addc_u32 s89, s45, 0
    s_load_dword s54, s[88:89], 0
    s_mov_b32 s46, 0xa50000
    s_mov_b32 s47, s7
    s_and_b32 s3, s48, 1
    s_bfe_u32 s69, s48, 0x10001
    v_bfe_u32 v6, v1, 2, 2
    v_lshrrev_b32 v32, 5, v1
    v_lshl_add_u32 v33, v32, 3, v6
    v_lshrrev_b32 v6, 1, v6
    v_xor_b32 v6, s3, v6
    v_lshlrev_b32 v6, 6, v6
    v_lshl_add_u32 v33, v33, 7, v6
    v_and_b32 v6, 16, v1
    v_lshl_add_u32 v33, v6, 1, v33
    v_and_b32 v6, 3, v1
    v_lshl_add_u32 v51, v6, 3, v33
    v_and_b32 v6, 31, v1
    v_xor_b32 v33, v32, v6
    v_and_b32 v33, 15, v33
    v_lshlrev_b32 v33, 4, v33
    v_lshl_add_u32 v6, s69, 5, v6
    v_lshl_add_u32 v50, v6, 8, v33
    v_and_b32 v33, 0x33, v1
    v_and_b32 v7, 4, v1
    v_lshl_or_b32 v33, v7, 1, v33
    v_and_b32 v7, 8, v1
    v_lshrrev_b32 v7, 1, v7
    v_or_b32 v6, v7, v33
    v_lshlrev_b32 v2, 4, v6
    v_and_b32 v7, 15, v1
    v_lshlrev_b32 v7, 4, v7
    v_lshl_add_u32 v33, v32, 8, v7
    v_bfe_u32 v6, v1, 4, 1
    v_lshl_add_u32 v3, v6, 17, v33
    s_lshl2_add_u32 s57, s3, s69
    s_lshl_b32 s58, s57, 11
    s_add_u32 s58, s58, 98304
    v_add_u32 v5, s58, v2
    v_lshl_add_u32 v6, v6, 12, v33
    v_add_u32 v11, s58, v6
    s_lshl_b32 s57, s57, 10
    v_lshl_add_u32 v14, v1, 4, s57
    s_lshl_b32 s57, s72, 11
    v_lshl_add_u32 v15, v1, 4, s57
    s_lshl2_add_u32 s57, s49, s72
    s_lshl_b32 s57, s57, 17
    v_lshl_add_u32 v9, v1, 4, s57
    v_add_u32 v10, s57, v33
    s_lshl_b32 s57, s72, 12
    s_add_u32 s57, s57, 98304
    v_lshl_add_u32 v48, v1, 4, s57
    v_add_u32 v49, s57, v33
    v_mov_b32 v8, 0xdddddddd
    s_mov_b32 s70, 0xffff
    s_mov_b32 s71, s70
    s_mov_b32 s68, 0x1ffff
    s_mov_b32 s66, 0
    v_and_b32 v7, 0x1b, v1
    v_cmp_eq_u32 vcc, 16, v7
    v_mov_b32 v6, 0x3f803f80
    s_add_u32 s64, s52, 1
    v_cndmask_b32 v12, 0, v6, vcc
    v_cndmask_b32 v13, 0, v6, vcc
    s_and_b32 s64, s64, 31
    s_lshl_b32 s64, s64, 12
    v_mov_b64 v[16:17], 0
    v_mov_b64 v[18:19], 0
    v_mov_b64 v[20:21], 0
    v_mov_b64 v[22:23], 0
    v_mov_b64 v[24:25], 0
    v_mov_b64 v[26:27], 0
    v_mov_b64 v[28:29], 0
    v_mov_b64 v[30:31], 0
    s_lshl1_add_u32 s57, s49, s3
    s_lshl_b32 s57, s57, 18
    s_lshl1_add_u32 s58, s52, s69
    s_lshl_b32 s58, s58, 11
    s_add_u32 s60, s57, s58
    s_add_u32 s59, s60, 0x20000
    s_lshr_b32 s14, s52, 3
    s_lshl2_add_u32 s14, s49, s14
    s_lshl2_add_u32 s14, s14, s48
    s_lshl_b32 s14, s14, 7
    s_add_u32 s14, s14, 10518528
    s_load_dword s15, s[44:45], s14
    s_lshr_b32 s16, s52, 2
    s_lshl3_add_u32 s16, s49, s16
    s_lshl2_add_u32 s16, s16, s48
    s_lshl_b32 s16, s16, 7
    s_add_u32 s16, s16, 10584064
    s_load_dword s17, s[44:45], s16
    s_lshl2_add_u32 s18, s51, s48
    s_lshl_b32 s18, s18, 7
    s_add_u32 s19, s18, 10551296
    s_add_u32 s18, s18, 10485760
    s_load_dword s20, s[44:45], s18
    s_load_dword s21, s[44:45], s19
    s_waitcnt lgkmcnt(0)
    s_mul_i32 s54, s54, 0x2c9277b5
    s_add_u32 s54, s54, 0xac564b05
    v_add_u32 v52, 0, v50
    v_add_u32 v53, 16384, v51
    s_barrier
    ds_read_b128 v[128:131], v52
    ds_read_b64_tr_b16 v[96:97], v53
    ds_read_b64_tr_b16 v[98:99], v53 offset:512
    ds_read_b64_tr_b16 v[100:101], v53 offset:16384
    ds_read_b64_tr_b16 v[102:103], v53 offset:16896
    v_xor_b32 v55, 32, v52
    ds_read_b128 v[132:135], v55
    ds_read_b64_tr_b16 v[104:105], v53 offset:2048
    ds_read_b64_tr_b16 v[106:107], v53 offset:2560
    ds_read_b64_tr_b16 v[108:109], v53 offset:18432
    ds_read_b64_tr_b16 v[110:111], v53 offset:18944
    s_waitcnt lgkmcnt(7)
    v_mfma_f32_32x32x16_bf16 v[64:79], v[96:99], v[128:131], 0
    v_xor_b32 v54, 64, v52
    ds_read_b128 v[136:139], v54
    ds_read_b64_tr_b16 v[112:113], v53 offset:4096
    ds_read_b64_tr_b16 v[114:115], v53 offset:4608
    s_waitcnt lgkmcnt(8)
    v_mfma_f32_32x32x16_bf16 v[80:95], v[128:131], v[100:103], 0
    ds_read_b64_tr_b16 v[116:117], v53 offset:20480
    ds_read_b64_tr_b16 v[118:119], v53 offset:20992
    s_waitcnt lgkmcnt(7)
    v_mfma_f32_32x32x16_bf16 v[64:79], v[104:107], v[132:135], v[64:79]
    v_xor_b32 v55, 96, v52
    ds_read_b128 v[140:143], v55
    ds_read_b64_tr_b16 v[120:121], v53 offset:6144
    ds_read_b64_tr_b16 v[122:123], v53 offset:6656
    s_waitcnt lgkmcnt(8)
    v_mfma_f32_32x32x16_bf16 v[80:95], v[132:135], v[108:111], v[80:95]
    ds_read_b64_tr_b16 v[124:125], v53 offset:22528
    ds_read_b64_tr_b16 v[126:127], v53 offset:23040
    s_waitcnt lgkmcnt(7)
    v_mfma_f32_32x32x16_bf16 v[64:79], v[112:115], v[136:139], v[64:79]
    v_xor_b32 v54, 128, v52
    s_barrier
    ds_read_b128 v[144:147], v54
    ds_read_b64_tr_b16 v[96:97], v53 offset:8192
    ds_read_b64_tr_b16 v[98:99], v53 offset:8704
    s_waitcnt lgkmcnt(8)
    v_mfma_f32_32x32x16_bf16 v[80:95], v[136:139], v[116:119], v[80:95]
    ds_read_b64_tr_b16 v[100:101], v53 offset:24576
    ds_read_b64_tr_b16 v[102:103], v53 offset:25088
    s_waitcnt lgkmcnt(7)
    v_mfma_f32_32x32x16_bf16 v[64:79], v[120:123], v[140:143], v[64:79]
    v_xor_b32 v55, 160, v52
    ds_read_b128 v[148:151], v55
    ds_read_b64_tr_b16 v[104:105], v53 offset:10240
    ds_read_b64_tr_b16 v[106:107], v53 offset:10752
    s_waitcnt lgkmcnt(8)
    v_mfma_f32_32x32x16_bf16 v[80:95], v[140:143], v[124:127], v[80:95]
    ds_read_b64_tr_b16 v[108:109], v53 offset:26624
    ds_read_b64_tr_b16 v[110:111], v53 offset:27136
    s_waitcnt lgkmcnt(7)
    v_mfma_f32_32x32x16_bf16 v[64:79], v[96:99], v[144:147], v[64:79]
    v_xor_b32 v54, 192, v52
    ds_read_b128 v[152:155], v54
    ds_read_b64_tr_b16 v[112:113], v53 offset:12288
    ds_read_b64_tr_b16 v[114:115], v53 offset:12800
    s_waitcnt lgkmcnt(8)
    v_mfma_f32_32x32x16_bf16 v[80:95], v[144:147], v[100:103], v[80:95]
    ds_read_b64_tr_b16 v[116:117], v53 offset:28672
    ds_read_b64_tr_b16 v[118:119], v53 offset:29184
    s_waitcnt lgkmcnt(7)
    v_mfma_f32_32x32x16_bf16 v[64:79], v[104:107], v[148:151], v[64:79]
    v_xor_b32 v55, 224, v52
    ds_read_b128 v[156:159], v55
    ds_read_b64_tr_b16 v[120:121], v53 offset:14336
    ds_read_b64_tr_b16 v[122:123], v53 offset:14848
    s_waitcnt lgkmcnt(8)
    v_mfma_f32_32x32x16_bf16 v[80:95], v[148:151], v[108:111], v[80:95]
    ds_read_b64_tr_b16 v[124:125], v53 offset:30720
    ds_read_b64_tr_b16 v[126:127], v53 offset:31232
    s_waitcnt lgkmcnt(7)
    v_mfma_f32_32x32x16_bf16 v[64:79], v[112:115], v[152:155], v[64:79]
    v_add_u32 v52, 49152, v50
    v_add_u32 v53, 65536, v51
    s_barrier
    ds_read_b128 v[160:163], v52
    ds_read_b64_tr_b16 v[96:97], v53
    ds_read_b64_tr_b16 v[98:99], v53 offset:512
    s_waitcnt lgkmcnt(8)
    v_mfma_f32_32x32x16_bf16 v[80:95], v[152:155], v[116:119], v[80:95]
    ds_read_b64_tr_b16 v[100:101], v53 offset:16384
    ds_read_b64_tr_b16 v[102:103], v53 offset:16896
    s_waitcnt lgkmcnt(7)
    v_mfma_f32_32x32x16_bf16 v[64:79], v[120:123], v[156:159], v[64:79]
    v_xor_b32 v55, 32, v52
    ds_read_b128 v[164:167], v55
    ds_read_b64_tr_b16 v[104:105], v53 offset:2048
    ds_read_b64_tr_b16 v[106:107], v53 offset:2560
    s_waitcnt lgkmcnt(8)
    v_mfma_f32_32x32x16_bf16 v[80:95], v[156:159], v[124:127], v[80:95]
    ds_read_b64_tr_b16 v[108:109], v53 offset:18432
    ds_read_b64_tr_b16 v[110:111], v53 offset:18944
    s_waitcnt lgkmcnt(7)
    v_mfma_f32_32x32x16_bf16 v[64:79], v[96:99], v[160:163], v[64:79]
    v_xor_b32 v54, 64, v52
    ds_read_b128 v[168:171], v54
    ds_read_b64_tr_b16 v[112:113], v53 offset:4096
    ds_read_b64_tr_b16 v[114:115], v53 offset:4608
    s_waitcnt lgkmcnt(8)
    v_mfma_f32_32x32x16_bf16 v[80:95], v[160:163], v[100:103], v[80:95]
    ds_read_b64_tr_b16 v[116:117], v53 offset:20480
    ds_read_b64_tr_b16 v[118:119], v53 offset:20992
    s_waitcnt lgkmcnt(7)
    v_mfma_f32_32x32x16_bf16 v[64:79], v[104:107], v[164:167], v[64:79]
    v_xor_b32 v55, 96, v52
    ds_read_b128 v[172:175], v55
    ds_read_b64_tr_b16 v[120:121], v53 offset:6144
    ds_read_b64_tr_b16 v[122:123], v53 offset:6656
    s_waitcnt lgkmcnt(8)
    v_mfma_f32_32x32x16_bf16 v[80:95], v[164:167], v[108:111], v[80:95]
    ds_read_b64_tr_b16 v[124:125], v53 offset:22528
    ds_read_b64_tr_b16 v[126:127], v53 offset:23040
    s_waitcnt lgkmcnt(7)
    v_mfma_f32_32x32x16_bf16 v[64:79], v[112:115], v[168:171], v[64:79]
    v_xor_b32 v54, 128, v52
    s_barrier
    ds_read_b128 v[176:179], v54
    ds_read_b64_tr_b16 v[96:97], v53 offset:8192
    ds_read_b64_tr_b16 v[98:99], v53 offset:8704
    s_waitcnt lgkmcnt(8)
    v_mfma_f32_32x32x16_bf16 v[80:95], v[168:171], v[116:119], v[80:95]
    ds_read_b64_tr_b16 v[100:101], v53 offset:24576
    ds_read_b64_tr_b16 v[102:103], v53 offset:25088
    s_waitcnt lgkmcnt(7)
    v_mfma_f32_32x32x16_bf16 v[64:79], v[120:123], v[172:175], v[64:79]
    v_xor_b32 v55, 160, v52
    ds_read_b128 v[180:183], v55
    ds_read_b64_tr_b16 v[104:105], v53 offset:10240
    ds_read_b64_tr_b16 v[106:107], v53 offset:10752
    s_waitcnt lgkmcnt(8)
    v_mfma_f32_32x32x16_bf16 v[80:95], v[172:175], v[124:127], v[80:95]
    ds_read_b64_tr_b16 v[108:109], v53 offset:26624
    ds_read_b64_tr_b16 v[110:111], v53 offset:27136
    s_waitcnt lgkmcnt(7)
    v_mfma_f32_32x32x16_bf16 v[64:79], v[96:99], v[176:179], v[64:79]
    v_xor_b32 v54, 192, v52
    ds_read_b128 v[184:187], v54
    ds_read_b64_tr_b16 v[112:113], v53 offset:12288
    ds_read_b64_tr_b16 v[114:115], v53 offset:12800
    s_waitcnt lgkmcnt(8)
    v_mfma_f32_32x32x16_bf16 v[80:95], v[176:179], v[100:103], v[80:95]
    ds_read_b64_tr_b16 v[116:117], v53 offset:28672
    ds_read_b64_tr_b16 v[118:119], v53 offset:29184
    s_waitcnt lgkmcnt(7)
    v_mfma_f32_32x32x16_bf16 v[64:79], v[104:107], v[180:183], v[64:79]
    v_xor_b32 v55, 224, v52
    ds_read_b128 v[188:191], v55
    ds_read_b64_tr_b16 v[120:121], v53 offset:14336
    ds_read_b64_tr_b16 v[122:123], v53 offset:14848
    s_waitcnt lgkmcnt(8)
    v_mfma_f32_32x32x16_bf16 v[80:95], v[180:183], v[108:111], v[80:95]
    ds_read_b64_tr_b16 v[124:125], v53 offset:30720
    ds_read_b64_tr_b16 v[126:127], v53 offset:31232
    s_waitcnt lgkmcnt(7)
    v_mfma_f32_32x32x16_bf16 v[64:79], v[112:115], v[184:187], v[64:79]
    v_add_u32 v52, 98304, v50
    v_add_u32 v53, 114688, v51
    s_barrier
    ds_read_b128 v[192:195], v52
    ds_read_b64_tr_b16 v[96:97], v53
    ds_read_b64_tr_b16 v[98:99], v53 offset:512
    s_waitcnt lgkmcnt(8)
    v_mfma_f32_32x32x16_bf16 v[80:95], v[184:187], v[116:119], v[80:95]
    ds_read_b64_tr_b16 v[100:101], v53 offset:16384
    ds_read_b64_tr_b16 v[102:103], v53 offset:16896
    s_waitcnt lgkmcnt(7)
    v_mfma_f32_32x32x16_bf16 v[64:79], v[120:123], v[188:191], v[64:79]
    v_xor_b32 v55, 32, v52
    ds_read_b128 v[196:199], v55
    ds_read_b64_tr_b16 v[104:105], v53 offset:2048
    ds_read_b64_tr_b16 v[106:107], v53 offset:2560
    s_waitcnt lgkmcnt(8)
    v_mfma_f32_32x32x16_bf16 v[80:95], v[188:191], v[124:127], v[80:95]
    ds_read_b64_tr_b16 v[108:109], v53 offset:18432
    ds_read_b64_tr_b16 v[110:111], v53 offset:18944
    s_waitcnt lgkmcnt(7)
    v_mfma_f32_32x32x16_bf16 v[64:79], v[96:99], v[192:195], v[64:79]
    v_xor_b32 v54, 64, v52
    ds_read_b128 v[200:203], v54
    ds_read_b64_tr_b16 v[112:113], v53 offset:4096
    ds_read_b64_tr_b16 v[114:115], v53 offset:4608
    s_waitcnt lgkmcnt(8)
    v_mfma_f32_32x32x16_bf16 v[80:95], v[192:195], v[100:103], v[80:95]
    ds_read_b64_tr_b16 v[116:117], v53 offset:20480
    ds_read_b64_tr_b16 v[118:119], v53 offset:20992
    s_waitcnt lgkmcnt(7)
    v_mfma_f32_32x32x16_bf16 v[64:79], v[104:107], v[196:199], v[64:79]
    v_xor_b32 v55, 96, v52
    ds_read_b128 v[204:207], v55
    ds_read_b64_tr_b16 v[120:121], v53 offset:6144
    ds_read_b64_tr_b16 v[122:123], v53 offset:6656
    s_waitcnt lgkmcnt(8)
    v_mfma_f32_32x32x16_bf16 v[80:95], v[196:199], v[108:111], v[80:95]
    ds_read_b64_tr_b16 v[124:125], v53 offset:22528
    ds_read_b64_tr_b16 v[126:127], v53 offset:23040
    s_waitcnt lgkmcnt(7)
    v_mfma_f32_32x32x16_bf16 v[64:79], v[112:115], v[200:203], v[64:79]
    v_xor_b32 v54, 128, v52
    s_barrier
    ds_read_b128 v[208:211], v54
    ds_read_b64_tr_b16 v[96:97], v53 offset:8192
    ds_read_b64_tr_b16 v[98:99], v53 offset:8704
    s_waitcnt lgkmcnt(8)
    v_mfma_f32_32x32x16_bf16 v[80:95], v[200:203], v[116:119], v[80:95]
    ds_read_b64_tr_b16 v[100:101], v53 offset:24576
    ds_read_b64_tr_b16 v[102:103], v53 offset:25088
    s_waitcnt lgkmcnt(7)
    v_mfma_f32_32x32x16_bf16 v[64:79], v[120:123], v[204:207], v[64:79]
    v_xor_b32 v55, 160, v52
    ds_read_b128 v[212:215], v55
    ds_read_b64_tr_b16 v[104:105], v53 offset:10240
    ds_read_b64_tr_b16 v[106:107], v53 offset:10752
    s_waitcnt lgkmcnt(8)
    v_mfma_f32_32x32x16_bf16 v[80:95], v[204:207], v[124:127], v[80:95]
    ds_read_b64_tr_b16 v[108:109], v53 offset:26624
    ds_read_b64_tr_b16 v[110:111], v53 offset:27136
    s_waitcnt lgkmcnt(7)
    v_mfma_f32_32x32x16_bf16 v[64:79], v[96:99], v[208:211], v[64:79]
    v_xor_b32 v54, 192, v52
    ds_read_b128 v[216:219], v54
    ds_read_b64_tr_b16 v[112:113], v53 offset:12288
    ds_read_b64_tr_b16 v[114:115], v53 offset:12800
    s_waitcnt lgkmcnt(8)
    v_mfma_f32_32x32x16_bf16 v[80:95], v[208:211], v[100:103], v[80:95]
    ds_read_b64_tr_b16 v[116:117], v53 offset:28672
    ds_read_b64_tr_b16 v[118:119], v53 offset:29184
    s_waitcnt lgkmcnt(7)
    v_mfma_f32_32x32x16_bf16 v[64:79], v[104:107], v[212:215], v[64:79]
    v_xor_b32 v55, 224, v52
    ds_read_b128 v[220:223], v55
    ds_read_b64_tr_b16 v[120:121], v53 offset:14336
    ds_read_b64_tr_b16 v[122:123], v53 offset:14848
    s_waitcnt lgkmcnt(8)
    v_mfma_f32_32x32x16_bf16 v[80:95], v[212:215], v[108:111], v[80:95]
    ds_read_b64_tr_b16 v[124:125], v53 offset:30720
    ds_read_b64_tr_b16 v[126:127], v53 offset:31232
    s_waitcnt lgkmcnt(7)
    v_mfma_f32_32x32x16_bf16 v[64:79], v[112:115], v[216:219], v[64:79]
    s_waitcnt lgkmcnt(5)
    v_mfma_f32_32x32x16_bf16 v[80:95], v[216:219], v[116:119], v[80:95]
    s_waitcnt lgkmcnt(2)
    v_mfma_f32_32x32x16_bf16 v[64:79], v[120:123], v[220:223], v[64:79]
    s_waitcnt lgkmcnt(0)
    v_mfma_f32_32x32x16_bf16 v[80:95], v[220:223], v[124:127], v[80:95]
    v_add_u32 v52, 147456, v50
    v_add_u32 v53, 16384, v51
    s_barrier
    ds_read_b128 v[224:227], v52
    ds_read_b64_tr_b16 v[96:97], v53
    ds_read_b64_tr_b16 v[98:99], v53 offset:512
    ds_read_b64_tr_b16 v[100:101], v53 offset:16384
    ds_read_b64_tr_b16 v[102:103], v53 offset:16896
    v_xor_b32 v55, 32, v52
    ds_read_b128 v[228:231], v55
    ds_read_b64_tr_b16 v[104:105], v53 offset:2048
    ds_read_b64_tr_b16 v[106:107], v53 offset:2560
    ds_read_b64_tr_b16 v[108:109], v53 offset:18432
    ds_read_b64_tr_b16 v[110:111], v53 offset:18944
    v_xor_b32 v54, 64, v52
    ds_read_b128 v[232:235], v54
    ds_read_b64_tr_b16 v[112:113], v53 offset:4096
    ds_read_b64_tr_b16 v[114:115], v53 offset:4608
    ds_read_b64_tr_b16 v[116:117], v53 offset:20480
    ds_read_b64_tr_b16 v[118:119], v53 offset:20992
    s_waitcnt lgkmcnt(12)
    v_mfma_f32_32x32x16_bf16 v[64:79], v[96:99], v[224:227], v[64:79]
    v_xor_b32 v55, 96, v52
    ds_read_b128 v[236:239], v55
    ds_read_b64_tr_b16 v[120:121], v53 offset:6144
    ds_read_b64_tr_b16 v[122:123], v53 offset:6656
    s_waitcnt lgkmcnt(13)
    v_mfma_f32_32x32x16_bf16 v[80:95], v[224:227], v[100:103], v[80:95]
    ds_read_b64_tr_b16 v[124:125], v53 offset:22528
    ds_read_b64_tr_b16 v[126:127], v53 offset:23040
    s_waitcnt lgkmcnt(12)
    v_mfma_f32_32x32x16_bf16 v[64:79], v[104:107], v[228:231], v[64:79]
    v_xor_b32 v54, 128, v52
    s_barrier
    ds_read_b128 v[240:243], v54
    ds_read_b64_tr_b16 v[96:97], v53 offset:8192
    ds_read_b64_tr_b16 v[98:99], v53 offset:8704
    s_waitcnt lgkmcnt(13)
    v_mfma_f32_32x32x16_bf16 v[80:95], v[228:231], v[108:111], v[80:95]
    ds_read_b64_tr_b16 v[100:101], v53 offset:24576
    ds_read_b64_tr_b16 v[102:103], v53 offset:25088
    s_waitcnt lgkmcnt(12)
    v_mfma_f32_32x32x16_bf16 v[64:79], v[112:115], v[232:235], v[64:79]
    v_xor_b32 v55, 160, v52
    ds_read_b128 v[244:247], v55
    ds_read_b64_tr_b16 v[104:105], v53 offset:10240
    ds_read_b64_tr_b16 v[106:107], v53 offset:10752
    s_waitcnt lgkmcnt(13)
    v_mfma_f32_32x32x16_bf16 v[80:95], v[232:235], v[116:119], v[80:95]
    ds_read_b64_tr_b16 v[108:109], v53 offset:26624
    ds_read_b64_tr_b16 v[110:111], v53 offset:27136
    s_waitcnt lgkmcnt(12)
    v_mfma_f32_32x32x16_bf16 v[64:79], v[120:123], v[236:239], v[64:79]
    v_xor_b32 v54, 192, v52
    ds_read_b128 v[248:251], v54
    ds_read_b64_tr_b16 v[112:113], v53 offset:12288
    ds_read_b64_tr_b16 v[114:115], v53 offset:12800
    s_waitcnt lgkmcnt(13)
    v_mfma_f32_32x32x16_bf16 v[80:95], v[236:239], v[124:127], v[80:95]
    ds_read_b64_tr_b16 v[116:117], v53 offset:28672
    ds_read_b64_tr_b16 v[118:119], v53 offset:29184
    s_waitcnt lgkmcnt(12)
    v_mfma_f32_32x32x16_bf16 v[64:79], v[96:99], v[240:243], v[64:79]
    v_xor_b32 v55, 224, v52
    ds_read_b128 v[252:255], v55
    ds_read_b64_tr_b16 v[120:121], v53 offset:14336
    ds_read_b64_tr_b16 v[122:123], v53 offset:14848
    s_waitcnt lgkmcnt(13)
    v_mfma_f32_32x32x16_bf16 v[80:95], v[240:243], v[100:103], v[80:95]
    ds_read_b64_tr_b16 v[124:125], v53 offset:30720
    ds_read_b64_tr_b16 v[126:127], v53 offset:31232
    s_waitcnt lgkmcnt(12)
    v_mfma_f32_32x32x16_bf16 v[64:79], v[104:107], v[244:247], v[64:79]
    s_waitcnt lgkmcnt(10)
    v_mfma_f32_32x32x16_bf16 v[80:95], v[244:247], v[108:111], v[80:95]
    s_waitcnt lgkmcnt(7)
    v_mfma_f32_32x32x16_bf16 v[64:79], v[112:115], v[248:251], v[64:79]
    s_waitcnt lgkmcnt(5)
    v_mfma_f32_32x32x16_bf16 v[80:95], v[248:251], v[116:119], v[80:95]
    s_waitcnt lgkmcnt(2)
    v_mfma_f32_32x32x16_bf16 v[64:79], v[120:123], v[252:255], v[64:79]
    s_waitcnt lgkmcnt(0)
    v_mfma_f32_32x32x16_bf16 v[80:95], v[252:255], v[124:127], v[80:95]
    v_mov_b32 v56, 142848
    ds_write_b128 v56, v[16:19]
    s_nop 7
    v_cvt_pk_bf16_f32 v32, v64, v65
    v_cvt_pk_bf16_f32 v33, v66, v67
    v_cvt_pk_bf16_f32 v34, v68, v69
    v_cvt_pk_bf16_f32 v35, v70, v71
    v_cvt_pk_bf16_f32 v36, v72, v73
    v_cvt_pk_bf16_f32 v37, v74, v75
    v_cvt_pk_bf16_f32 v38, v76, v77
    v_cvt_pk_bf16_f32 v39, v78, v79
    buffer_store_dwordx4 v[32:35], v2, s[44:47], s60 offen sc1
    buffer_store_dwordx4 v[36:39], v2, s[44:47], s59 offen sc1
    v_cvt_pk_bf16_f32 v40, v80, v81
    v_cvt_pk_bf16_f32 v41, v82, v83
    v_cvt_pk_bf16_f32 v42, v84, v85
    v_cvt_pk_bf16_f32 v43, v86, v87
    v_cvt_pk_bf16_f32 v44, v88, v89
    v_cvt_pk_bf16_f32 v45, v90, v91
    v_cvt_pk_bf16_f32 v46, v92, v93
    v_cvt_pk_bf16_f32 v47, v94, v95
    buffer_store_dwordx4 v[40:43], v3, s[44:47], s60 offen offset:1024 sc1
    buffer_store_dwordx4 v[44:47], v3, s[44:47], s60 offen offset:1536 sc1
    ds_write_b128 v5, v[32:35]
    ds_write_b128 v5, v[36:39] offset:4096
    ds_write_b128 v11, v[40:43] offset:1024
    ds_write_b128 v11, v[44:47] offset:1536
    s_lshr_b32 s57, s52, 3
    s_mul_i32 s57, s57, 96
    s_lshl2_add_u32 s57, s52, s57
    s_lshl_b32 s60, s49, 11
    s_add_u32 s60, s60, 10518528
    s_add_u32 s57, s57, s60
    s_lshr_b32 s58, s52, 3
    s_lshl_b32 s58, s58, 9
    s_add_u32 s60, s60, s58
    s_waitcnt lgkmcnt(0)
    s_barrier
    v_add_u32 v54, 0, v51
    ds_read_b64_tr_b16 v[96:97], v54
    ds_read_b64_tr_b16 v[98:99], v54 offset:512
    ds_read_b64_tr_b16 v[100:101], v54 offset:2048
    ds_read_b64_tr_b16 v[102:103], v54 offset:2560
    ds_read_b64_tr_b16 v[104:105], v54 offset:4096
    ds_read_b64_tr_b16 v[106:107], v54 offset:4608
    ds_read_b64_tr_b16 v[108:109], v54 offset:6144
    ds_read_b64_tr_b16 v[110:111], v54 offset:6656
    s_waitcnt lgkmcnt(6)
    v_mfma_f32_32x32x16_bf16 v[64:79], v[96:99], v[128:131], 0
    ds_read_b64_tr_b16 v[112:113], v54 offset:8192
    ds_read_b64_tr_b16 v[114:115], v54 offset:8704
    v_and_b32 v6, 0xfffffe00, v48
    ds_read_b128 v[80:83], v6
    s_waitcnt lgkmcnt(7)
    v_mfma_f32_32x32x16_bf16 v[64:79], v[100:103], v[132:135], v[64:79]
    ds_read_b64_tr_b16 v[116:117], v54 offset:10240
    ds_read_b64_tr_b16 v[118:119], v54 offset:10752
    s_waitcnt lgkmcnt(7)
    v_mfma_f32_32x32x16_bf16 v[64:79], v[104:107], v[136:139], v[64:79]
    ds_read_b64_tr_b16 v[120:121], v54 offset:12288
    ds_read_b64_tr_b16 v[122:123], v54 offset:12800
    s_waitcnt lgkmcnt(7)
    v_mfma_f32_32x32x16_bf16 v[64:79], v[108:111], v[140:143], v[64:79]
    ds_read_b64_tr_b16 v[124:125], v54 offset:14336
    ds_read_b64_tr_b16 v[126:127], v54 offset:14848
    s_waitcnt lgkmcnt(7)
    v_mfma_f32_32x32x16_bf16 v[64:79], v[112:115], v[144:147], v[64:79]
    v_add_u32 v55, 49152, v51
    ds_read_b64_tr_b16 v[96:97], v55
    ds_read_b64_tr_b16 v[98:99], v55 offset:512
    s_waitcnt lgkmcnt(6)
    v_mfma_f32_32x32x16_bf16 v[64:79], v[116:119], v[148:151], v[64:79]
    ds_read_b64_tr_b16 v[100:101], v55 offset:2048
    ds_read_b64_tr_b16 v[102:103], v55 offset:2560
    s_waitcnt lgkmcnt(6)
    v_mfma_f32_32x32x16_bf16 v[64:79], v[120:123], v[152:155], v[64:79]
    ds_read_b64_tr_b16 v[104:105], v55 offset:4096
    ds_read_b64_tr_b16 v[106:107], v55 offset:4608
    v_xor_b32 v80, 0x80008000, v80
    v_xor_b32 v81, 0x80008000, v81
    v_xor_b32 v82, 0x80008000, v82
    v_xor_b32 v83, 0x80008000, v83
    s_waitcnt lgkmcnt(6)
    v_mfma_f32_32x32x16_bf16 v[64:79], v[124:127], v[156:159], v[64:79]
    ds_read_b64_tr_b16 v[108:109], v55 offset:6144
    ds_read_b64_tr_b16 v[110:111], v55 offset:6656
    s_waitcnt lgkmcnt(6)
    v_mfma_f32_32x32x16_bf16 v[64:79], v[96:99], v[160:163], v[64:79]
    ds_read_b64_tr_b16 v[112:113], v55 offset:8192
    ds_read_b64_tr_b16 v[114:115], v55 offset:8704
    v_mov_b64 v[132:133], v[12:13]
    v_mov_b64 v[134:135], v[12:13]
    v_mov_b64 v[136:137], v[12:13]
    v_mov_b64 v[138:139], v[12:13]
    s_waitcnt lgkmcnt(6)
    v_mfma_f32_32x32x16_bf16 v[64:79], v[100:103], v[164:167], v[64:79]
    ds_read_b64_tr_b16 v[116:117], v55 offset:10240
    ds_read_b64_tr_b16 v[118:119], v55 offset:10752
    v_mov_b64 v[144:145], v[12:13]
    v_mov_b64 v[146:147], v[12:13]
    v_mov_b64 v[148:149], v[12:13]
    v_mov_b64 v[150:151], v[12:13]
    s_waitcnt lgkmcnt(6)
    v_mfma_f32_32x32x16_bf16 v[64:79], v[104:107], v[168:171], v[64:79]
    ds_read_b64_tr_b16 v[120:121], v55 offset:12288
    ds_read_b64_tr_b16 v[122:123], v55 offset:12800
    ds_read_b128 v[128:131], v48
    ds_read_b128 v[140:143], v48 offset:2048
    s_waitcnt lgkmcnt(8)
    v_mfma_f32_32x32x16_bf16 v[64:79], v[108:111], v[172:175], v[64:79]
    ds_read_b64_tr_b16 v[124:125], v55 offset:14336
    ds_read_b64_tr_b16 v[126:127], v55 offset:14848
    s_mov_b64 exec, s[70:71]
    ds_read_b128 v[132:135], v49 offset:1024
    ds_read_b128 v[136:139], v49 offset:1536
    s_mov_b64 exec, -1
    s_waitcnt lgkmcnt(10)
    v_mfma_f32_32x32x16_bf16 v[64:79], v[112:115], v[176:179], v[64:79]
    v_add_u32 v54, 65536, v51
    s_waitcnt vmcnt(0)
    s_barrier
    ds_read_b64_tr_b16 v[96:97], v54
    ds_read_b64_tr_b16 v[98:99], v54 offset:512
    s_mov_b64 exec, s[70:71]
    ds_read_b128 v[144:147], v49 offset:3072
    ds_read_b128 v[148:151], v49 offset:3584
    s_mov_b64 exec, -1
    s_waitcnt lgkmcnt(12)
    v_mfma_f32_32x32x16_bf16 v[64:79], v[116:119], v[180:183], v[64:79]
    ds_read_b64_tr_b16 v[100:101], v54 offset:2048
    ds_read_b64_tr_b16 v[102:103], v54 offset:2560
    s_waitcnt lgkmcnt(12)
    v_mfma_f32_32x32x16_bf16 v[64:79], v[120:123], v[184:187], v[64:79]
    ds_read_b64_tr_b16 v[104:105], v54 offset:4096
    ds_read_b64_tr_b16 v[106:107], v54 offset:4608
    s_waitcnt lgkmcnt(10)
    v_mfma_f32_32x32x16_bf16 v[64:79], v[124:127], v[188:191], v[64:79]
    ds_read_b64_tr_b16 v[108:109], v54 offset:6144
    ds_read_b64_tr_b16 v[110:111], v54 offset:6656
    s_waitcnt lgkmcnt(8)
    v_mfma_f32_32x32x16_bf16 v[64:79], v[96:99], v[192:195], v[64:79]
    ds_read_b64_tr_b16 v[112:113], v54 offset:8192
    ds_read_b64_tr_b16 v[114:115], v54 offset:8704
    s_waitcnt lgkmcnt(6)
    v_mfma_f32_32x32x16_bf16 v[64:79], v[100:103], v[196:199], v[64:79]
    ds_read_b64_tr_b16 v[116:117], v54 offset:10240
    ds_read_b64_tr_b16 v[118:119], v54 offset:10752
    s_waitcnt lgkmcnt(6)
    v_mfma_f32_32x32x16_bf16 v[64:79], v[104:107], v[200:203], v[64:79]
    ds_read_b64_tr_b16 v[120:121], v54 offset:12288
    ds_read_b64_tr_b16 v[122:123], v54 offset:12800
    s_waitcnt lgkmcnt(6)
    v_mfma_f32_32x32x16_bf16 v[64:79], v[108:111], v[204:207], v[64:79]
    ds_read_b64_tr_b16 v[124:125], v54 offset:14336
    ds_read_b64_tr_b16 v[126:127], v54 offset:14848
    s_waitcnt lgkmcnt(6)
    v_mfma_f32_32x32x16_bf16 v[64:79], v[112:115], v[208:211], v[64:79]
    v_add_u32 v55, 81920, v51
    ds_read_b64_tr_b16 v[96:97], v55
    ds_read_b64_tr_b16 v[98:99], v55 offset:512
    s_waitcnt lgkmcnt(6)
    v_mfma_f32_32x32x16_bf16 v[64:79], v[116:119], v[212:215], v[64:79]
    ds_read_b64_tr_b16 v[100:101], v55 offset:2048
    ds_read_b64_tr_b16 v[102:103], v55 offset:2560
    v_mov_b64 v[156:157], v[12:13]
    v_mov_b64 v[158:159], v[12:13]
    v_mov_b64 v[160:161], v[12:13]
    v_mov_b64 v[162:163], v[12:13]
    s_waitcnt lgkmcnt(6)
    v_mfma_f32_32x32x16_bf16 v[64:79], v[120:123], v[216:219], v[64:79]
    ds_read_b64_tr_b16 v[104:105], v55 offset:4096
    ds_read_b64_tr_b16 v[106:107], v55 offset:4608
    v_mov_b64 v[168:169], v[12:13]
    v_mov_b64 v[170:171], v[12:13]
    v_mov_b64 v[172:173], v[12:13]
    v_mov_b64 v[174:175], v[12:13]
    s_waitcnt lgkmcnt(6)
    v_mfma_f32_32x32x16_bf16 v[64:79], v[124:127], v[220:223], v[64:79]
    ds_read_b64_tr_b16 v[108:109], v55 offset:6144
    ds_read_b64_tr_b16 v[110:111], v55 offset:6656
    v_mov_b64 v[180:181], v[12:13]
    v_mov_b64 v[182:183], v[12:13]
    v_mov_b64 v[184:185], v[12:13]
    v_mov_b64 v[186:187], v[12:13]
    s_waitcnt lgkmcnt(6)
    v_mfma_f32_32x32x16_bf16 v[64:79], v[96:99], v[224:227], v[64:79]
    ds_read_b64_tr_b16 v[112:113], v55 offset:8192
    ds_read_b64_tr_b16 v[114:115], v55 offset:8704
    v_mov_b64 v[192:193], v[12:13]
    v_mov_b64 v[194:195], v[12:13]
    v_mov_b64 v[196:197], v[12:13]
    v_mov_b64 v[198:199], v[12:13]
    s_waitcnt lgkmcnt(6)
    v_mfma_f32_32x32x16_bf16 v[64:79], v[100:103], v[228:231], v[64:79]
    ds_read_b64_tr_b16 v[116:117], v55 offset:10240
    ds_read_b64_tr_b16 v[118:119], v55 offset:10752
    v_mov_b64 v[204:205], v[12:13]
    v_mov_b64 v[206:207], v[12:13]
    v_mov_b64 v[208:209], v[12:13]
    v_mov_b64 v[210:211], v[12:13]
    s_waitcnt lgkmcnt(6)
    v_mfma_f32_32x32x16_bf16 v[64:79], v[104:107], v[232:235], v[64:79]
    ds_read_b64_tr_b16 v[120:121], v55 offset:12288
    ds_read_b64_tr_b16 v[122:123], v55 offset:12800
    v_mov_b64 v[216:217], v[12:13]
    v_mov_b64 v[218:219], v[12:13]
    v_mov_b64 v[220:221], v[12:13]
    v_mov_b64 v[222:223], v[12:13]
    s_waitcnt lgkmcnt(6)
    v_mfma_f32_32x32x16_bf16 v[64:79], v[108:111], v[236:239], v[64:79]
    ds_read_b64_tr_b16 v[124:125], v55 offset:14336
    ds_read_b64_tr_b16 v[126:127], v55 offset:14848
    s_waitcnt lgkmcnt(6)
    v_mfma_f32_32x32x16_bf16 v[64:79], v[112:115], v[240:243], v[64:79]
    v_mov_b64 v[32:33], 0
    v_mov_b64 v[34:35], 0
    v_mov_b64 v[36:37], 0
    v_mov_b64 v[38:39], 0
    s_waitcnt lgkmcnt(4)
    v_mfma_f32_32x32x16_bf16 v[64:79], v[116:119], v[244:247], v[64:79]
    v_mov_b64 v[40:41], 0
    v_mov_b64 v[42:43], 0
    v_mov_b64 v[44:45], 0
    v_mov_b64 v[46:47], 0
    s_barrier
    s_waitcnt lgkmcnt(2)
    v_mfma_f32_32x32x16_bf16 v[64:79], v[120:123], v[248:251], v[64:79]
    s_waitcnt lgkmcnt(0)
    v_mfma_f32_32x32x16_bf16 v[64:79], v[124:127], v[252:255], v[64:79]
    s_setprio 1
    s_mov_b32 s59, 0x3eb8aa3b
    s_mov_b32 s58, s59
    v_mov_b32 v2, v56
    v_mov_b32 v3, 1
    s_nop 0
    s_mov_b32 s65, 0
    s_nop 4
    v_pk_mul_f32 v[64:65], v[64:65], s[58:59]
    v_pk_mul_f32 v[66:67], v[66:67], s[58:59]
    v_pk_mul_f32 v[68:69], v[68:69], s[58:59]
    v_pk_mul_f32 v[70:71], v[70:71], s[58:59]
    v_pk_mul_f32 v[72:73], v[72:73], s[58:59]
    v_pk_mul_f32 v[74:75], v[74:75], s[58:59]
    v_pk_mul_f32 v[76:77], v[76:77], s[58:59]
    v_pk_mul_f32 v[78:79], v[78:79], s[58:59]
    v_cvt_pk_bf16_f32 v120, v64, v65
    v_cvt_pk_bf16_f32 v121, v66, v67
    v_cvt_pk_bf16_f32 v122, v68, v69
    v_cvt_pk_bf16_f32 v123, v70, v71
    v_cvt_pk_bf16_f32 v124, v72, v73
    v_cvt_pk_bf16_f32 v125, v74, v75
    v_cvt_pk_bf16_f32 v126, v76, v77
    v_cvt_pk_bf16_f32 v127, v78, v79
    ds_write_b128 v14, v[120:123] offset:16384
    ds_write_b128 v14, v[124:127] offset:18432
    v_mov_b64 v[72:73], 0
    v_mov_b64 v[74:75], 0
    v_mov_b64 v[76:77], 0
    v_mov_b64 v[78:79], 0
    v_mov_b64 v[64:65], v[80:81]
    v_mov_b64 v[66:67], v[82:83]
    s_waitcnt lgkmcnt(0)
    s_barrier
    ds_read_b128 v[112:115], v15 offset:16384
    ds_read_b128 v[116:119], v15 offset:17408
    s_waitcnt lgkmcnt(0)
    v_mfma_f32_32x32x16_bf16 v[80:95], v[64:67], v[112:115], 0
    v_mfma_f32_32x32x16_bf16 v[48:63], v[128:131], v[112:115], v[80:95]
    v_mfma_f32_32x32x16_bf16 v[96:111], v[64:67], v[116:119], 0
    s_barrier
    s_add_u32 s12, s44, s64
    s_addc_u32 s13, s45, 0
    global_load_dwordx4 v[152:155], v9, s[12:13] offset:0 sc1
    s_mov_b64 exec, s[70:71]
    global_load_dwordx4 v[156:159], v10, s[12:13] offset:1024 sc1
    global_load_dwordx4 v[160:163], v10, s[12:13] offset:1536 sc1
    s_mov_b64 exec, -1
    global_load_dwordx4 v[164:167], v9, s[12:13] offset:2048 sc1
    s_mov_b64 exec, s[70:71]
    global_load_dwordx4 v[168:171], v10, s[12:13] offset:3072 sc1
    global_load_dwordx4 v[172:175], v10, s[12:13] offset:3584 sc1
    s_mov_b64 exec, -1
    s_add_u32 s64, s64, 0x1000
    s_and_b32 s64, s64, s68
    s_add_u32 s12, s44, s64
    s_addc_u32 s13, s45, 0
    global_load_dwordx4 v[176:179], v9, s[12:13] offset:0 sc1
    s_mov_b64 exec, s[70:71]
    global_load_dwordx4 v[180:183], v10, s[12:13] offset:1024 sc1
    global_load_dwordx4 v[184:187], v10, s[12:13] offset:1536 sc1
    s_mov_b64 exec, -1
    s_mov_b64 exec, 1
    ds_add_u32 v2, v3
    s_mov_b64 exec, -1
L_fill:
.p2align 6
L_loop:
    v_exp_f32 v48, v48
    v_exp_f32 v49, v49
    v_smfmac_f32_32x32x32_bf16 v[32:47], v[220:223], v[72:79], v8
    s_mov_b64 exec, s[70:71]
    global_load_dwordx4 v[192:195], v10, s[12:13] offset:3072 sc1
    global_load_dwordx4 v[196:199], v10, s[12:13] offset:3584 sc1
    s_mov_b64 exec, -1
    v_exp_f32 v50, v50
    v_exp_f32 v51, v51
    v_exp_f32 v52, v52
    v_exp_f32 v53, v53
    v_mfma_f32_32x32x16_bf16 v[64:79], v[128:131], v[116:119], v[96:111]
    global_load_dwordx4 v[188:191], v9, s[12:13] offset:2048 sc1
    v_exp_f32 v54, v54
    v_exp_f32 v55, v55
    v_exp_f32 v56, v56
    v_exp_f32 v57, v57
    v_smfmac_f32_32x32x32_bf16 v[16:31], v[132:135], v[48:55], v8
    s_add_u32 s64, s64, 0x1000
    s_and_b32 s64, s64, s68
    v_exp_f32 v58, v58
    v_exp_f32 v59, v59
    v_exp_f32 v60, v60
    v_exp_f32 v61, v61
    v_exp_f32 v62, v62
    v_exp_f32 v63, v63
    v_exp_f32 v64, v64
    v_exp_f32 v65, v65
    v_smfmac_f32_32x32x32_bf16 v[16:31], v[136:139], v[56:63], v8
    s_waitcnt vmcnt(12)
    v_exp_f32 v66, v66
    v_exp_f32 v67, v67
    v_exp_f32 v68, v68
    v_exp_f32 v69, v69
    v_mfma_f32_32x32x16_bf16 v[48:63], v[140:143], v[112:115], v[80:95]
    s_nop 0
    v_exp_f32 v70, v70
    v_exp_f32 v71, v71
    v_exp_f32 v72, v72
    v_exp_f32 v73, v73
    v_smfmac_f32_32x32x32_bf16 v[32:47], v[132:135], v[64:71], v8
    s_add_u32 s12, s44, s64
    s_addc_u32 s13, s45, 0
    v_exp_f32 v74, v74
    v_exp_f32 v75, v75
    v_exp_f32 v76, v76
    v_exp_f32 v77, v77
    v_exp_f32 v78, v78
    v_exp_f32 v79, v79
    v_exp_f32 v48, v48
    v_exp_f32 v49, v49
    v_smfmac_f32_32x32x32_bf16 v[32:47], v[136:139], v[72:79], v8
    s_mov_b64 exec, s[70:71]
    global_load_dwordx4 v[204:207], v10, s[12:13] offset:1024 sc1
    global_load_dwordx4 v[208:211], v10, s[12:13] offset:1536 sc1
    s_mov_b64 exec, -1
    v_exp_f32 v50, v50
    v_exp_f32 v51, v51
    v_exp_f32 v52, v52
    v_exp_f32 v53, v53
    v_mfma_f32_32x32x16_bf16 v[64:79], v[140:143], v[116:119], v[96:111]
    global_load_dwordx4 v[200:203], v9, s[12:13] offset:0 sc1
    v_exp_f32 v54, v54
    v_exp_f32 v55, v55
    v_exp_f32 v56, v56
    v_exp_f32 v57, v57
    v_smfmac_f32_32x32x32_bf16 v[16:31], v[144:147], v[48:55], v8
    v_exp_f32 v58, v58
    v_exp_f32 v59, v59
    v_exp_f32 v60, v60
    v_exp_f32 v61, v61
    v_exp_f32 v62, v62
    v_exp_f32 v63, v63
    v_exp_f32 v64, v64
    v_exp_f32 v65, v65
    v_smfmac_f32_32x32x32_bf16 v[16:31], v[148:151], v[56:63], v8
    s_waitcnt vmcnt(12)
    v_exp_f32 v66, v66
    v_exp_f32 v67, v67
    v_exp_f32 v68, v68
    v_exp_f32 v69, v69
    v_mfma_f32_32x32x16_bf16 v[48:63], v[152:155], v[112:115], v[80:95]
    s_nop 0
    v_exp_f32 v70, v70
    v_exp_f32 v71, v71
    v_exp_f32 v72, v72
    v_exp_f32 v73, v73
    v_smfmac_f32_32x32x32_bf16 v[32:47], v[144:147], v[64:71], v8
    v_exp_f32 v74, v74
    v_exp_f32 v75, v75
    v_exp_f32 v76, v76
    v_exp_f32 v77, v77
    v_exp_f32 v78, v78
    v_exp_f32 v79, v79
L_loop2:
    v_exp_f32 v48, v48
    v_exp_f32 v49, v49
    v_smfmac_f32_32x32x32_bf16 v[32:47], v[148:151], v[72:79], v8
    s_mov_b64 exec, s[70:71]
    global_load_dwordx4 v[216:219], v10, s[12:13] offset:3072 sc1
    global_load_dwordx4 v[220:223], v10, s[12:13] offset:3584 sc1
    s_mov_b64 exec, -1
    v_exp_f32 v50, v50
    v_exp_f32 v51, v51
    v_exp_f32 v52, v52
    v_exp_f32 v53, v53
    v_mfma_f32_32x32x16_bf16 v[64:79], v[152:155], v[116:119], v[96:111]
    global_load_dwordx4 v[212:215], v9, s[12:13] offset:2048 sc1
    v_exp_f32 v54, v54
    v_exp_f32 v55, v55
    v_exp_f32 v56, v56
    v_exp_f32 v57, v57
    v_smfmac_f32_32x32x32_bf16 v[16:31], v[156:159], v[48:55], v8
    s_add_u32 s64, s64, 0x1000
    s_and_b32 s64, s64, s68
    v_exp_f32 v58, v58
    v_exp_f32 v59, v59
    v_exp_f32 v60, v60
    v_exp_f32 v61, v61
    v_exp_f32 v62, v62
    v_exp_f32 v63, v63
    v_exp_f32 v64, v64
    v_exp_f32 v65, v65
    v_smfmac_f32_32x32x32_bf16 v[16:31], v[160:163], v[56:63], v8
    s_waitcnt vmcnt(12)
    v_exp_f32 v66, v66
    v_exp_f32 v67, v67
    v_exp_f32 v68, v68
    v_exp_f32 v69, v69
    v_mfma_f32_32x32x16_bf16 v[48:63], v[164:167], v[112:115], v[80:95]
    s_nop 0
    v_exp_f32 v70, v70
    v_exp_f32 v71, v71
    v_exp_f32 v72, v72
    v_exp_f32 v73, v73
    v_smfmac_f32_32x32x32_bf16 v[32:47], v[156:159], v[64:71], v8
    s_add_u32 s12, s44, s64
    s_addc_u32 s13, s45, 0
    v_exp_f32 v74, v74
    v_exp_f32 v75, v75
    v_exp_f32 v76, v76
    v_exp_f32 v77, v77
    v_exp_f32 v78, v78
    v_exp_f32 v79, v79
    v_exp_f32 v48, v48
    v_exp_f32 v49, v49
    v_smfmac_f32_32x32x32_bf16 v[32:47], v[160:163], v[72:79], v8
    s_mov_b64 exec, s[70:71]
    global_load_dwordx4 v[132:135], v10, s[12:13] offset:1024 sc1
    global_load_dwordx4 v[136:139], v10, s[12:13] offset:1536 sc1
    s_mov_b64 exec, -1
    v_exp_f32 v50, v50
    v_exp_f32 v51, v51
    v_exp_f32 v52, v52
    v_exp_f32 v53, v53
    v_mfma_f32_32x32x16_bf16 v[64:79], v[164:167], v[116:119], v[96:111]
    global_load_dwordx4 v[128:131], v9, s[12:13] offset:0 sc1
    v_exp_f32 v54, v54
    v_exp_f32 v55, v55
    v_exp_f32 v56, v56
    v_exp_f32 v57, v57
    v_smfmac_f32_32x32x32_bf16 v[16:31], v[168:171], v[48:55], v8
    v_exp_f32 v58, v58
    v_exp_f32 v59, v59
    v_exp_f32 v60, v60
    v_exp_f32 v61, v61
    v_exp_f32 v62, v62
    v_exp_f32 v63, v63
    v_exp_f32 v64, v64
    v_exp_f32 v65, v65
    v_smfmac_f32_32x32x32_bf16 v[16:31], v[172:175], v[56:63], v8
    s_waitcnt vmcnt(12)
    v_exp_f32 v66, v66
    v_exp_f32 v67, v67
    v_exp_f32 v68, v68
    v_exp_f32 v69, v69
    v_mfma_f32_32x32x16_bf16 v[48:63], v[176:179], v[112:115], v[80:95]
    s_nop 0
    v_exp_f32 v70, v70
    v_exp_f32 v71, v71
    v_exp_f32 v72, v72
    v_exp_f32 v73, v73
    v_smfmac_f32_32x32x32_bf16 v[32:47], v[168:171], v[64:71], v8
    v_exp_f32 v74, v74
    v_exp_f32 v75, v75
    v_exp_f32 v76, v76
    v_exp_f32 v77, v77
    v_exp_f32 v78, v78
    v_exp_f32 v79, v79
    v_exp_f32 v48, v48
    v_exp_f32 v49, v49
    v_smfmac_f32_32x32x32_bf16 v[32:47], v[172:175], v[72:79], v8
    s_mov_b64 exec, s[70:71]
    global_load_dwordx4 v[144:147], v10, s[12:13] offset:3072 sc1
    global_load_dwordx4 v[148:151], v10, s[12:13] offset:3584 sc1
    s_mov_b64 exec, -1
    v_exp_f32 v50, v50
    v_exp_f32 v51, v51
    v_exp_f32 v52, v52
    v_exp_f32 v53, v53
    v_mfma_f32_32x32x16_bf16 v[64:79], v[176:179], v[116:119], v[96:111]
    global_load_dwordx4 v[140:143], v9, s[12:13] offset:2048 sc1
    v_exp_f32 v54, v54
    v_exp_f32 v55, v55
    v_exp_f32 v56, v56
    v_exp_f32 v57, v57
    v_smfmac_f32_32x32x32_bf16 v[16:31], v[180:183], v[48:55], v8
    s_add_u32 s64, s64, 0x1000
    s_and_b32 s64, s64, s68
    v_exp_f32 v58, v58
    v_exp_f32 v59, v59
    v_exp_f32 v60, v60
    v_exp_f32 v61, v61
    v_exp_f32 v62, v62
    v_exp_f32 v63, v63
    v_exp_f32 v64, v64
    v_exp_f32 v65, v65
    v_smfmac_f32_32x32x32_bf16 v[16:31], v[184:187], v[56:63], v8
    s_waitcnt vmcnt(12)
    v_exp_f32 v66, v66
    v_exp_f32 v67, v67
    v_exp_f32 v68, v68
    v_exp_f32 v69, v69
    v_mfma_f32_32x32x16_bf16 v[48:63], v[188:191], v[112:115], v[80:95]
    s_nop 0
    v_exp_f32 v70, v70
    v_exp_f32 v71, v71
    v_exp_f32 v72, v72
    v_exp_f32 v73, v73
    v_smfmac_f32_32x32x32_bf16 v[32:47], v[180:183], v[64:71], v8
    s_add_u32 s12, s44, s64
    s_addc_u32 s13, s45, 0
    v_exp_f32 v74, v74
    v_exp_f32 v75, v75
    v_exp_f32 v76, v76
    v_exp_f32 v77, v77
    v_exp_f32 v78, v78
    v_exp_f32 v79, v79
    v_exp_f32 v48, v48
    v_exp_f32 v49, v49
    v_smfmac_f32_32x32x32_bf16 v[32:47], v[184:187], v[72:79], v8
    s_mov_b64 exec, s[70:71]
    global_load_dwordx4 v[156:159], v10, s[12:13] offset:1024 sc1
    global_load_dwordx4 v[160:163], v10, s[12:13] offset:1536 sc1
    s_mov_b64 exec, -1
    v_exp_f32 v50, v50
    v_exp_f32 v51, v51
    v_exp_f32 v52, v52
    v_exp_f32 v53, v53
    v_mfma_f32_32x32x16_bf16 v[64:79], v[188:191], v[116:119], v[96:111]
    global_load_dwordx4 v[152:155], v9, s[12:13] offset:0 sc1
    v_exp_f32 v54, v54
    v_exp_f32 v55, v55
    v_exp_f32 v56, v56
    v_exp_f32 v57, v57
    v_smfmac_f32_32x32x32_bf16 v[16:31], v[192:195], v[48:55], v8
    v_exp_f32 v58, v58
    v_exp_f32 v59, v59
    v_exp_f32 v60, v60
    v_exp_f32 v61, v61
    v_exp_f32 v62, v62
    v_exp_f32 v63, v63
    v_exp_f32 v64, v64
    v_exp_f32 v65, v65
    v_smfmac_f32_32x32x32_bf16 v[16:31], v[196:199], v[56:63], v8
    s_waitcnt vmcnt(12)
    v_exp_f32 v66, v66
    v_exp_f32 v67, v67
    v_exp_f32 v68, v68
    v_exp_f32 v69, v69
    v_mfma_f32_32x32x16_bf16 v[48:63], v[200:203], v[112:115], v[80:95]
    s_nop 0
    v_exp_f32 v70, v70
    v_exp_f32 v71, v71
    v_exp_f32 v72, v72
    v_exp_f32 v73, v73
    v_smfmac_f32_32x32x32_bf16 v[32:47], v[192:195], v[64:71], v8
    v_exp_f32 v74, v74
    v_exp_f32 v75, v75
    v_exp_f32 v76, v76
    v_exp_f32 v77, v77
    v_exp_f32 v78, v78
    v_exp_f32 v79, v79
    v_exp_f32 v48, v48
    v_exp_f32 v49, v49
    v_smfmac_f32_32x32x32_bf16 v[32:47], v[196:199], v[72:79], v8
    s_mov_b64 exec, s[70:71]
    global_load_dwordx4 v[168:171], v10, s[12:13] offset:3072 sc1
    global_load_dwordx4 v[172:175], v10, s[12:13] offset:3584 sc1
    s_mov_b64 exec, -1
    v_exp_f32 v50, v50
    v_exp_f32 v51, v51
    v_exp_f32 v52, v52
    v_exp_f32 v53, v53
    v_mfma_f32_32x32x16_bf16 v[64:79], v[200:203], v[116:119], v[96:111]
    global_load_dwordx4 v[164:167], v9, s[12:13] offset:2048 sc1
    v_exp_f32 v54, v54
    v_exp_f32 v55, v55
    v_exp_f32 v56, v56
    v_exp_f32 v57, v57
    v_smfmac_f32_32x32x32_bf16 v[16:31], v[204:207], v[48:55], v8
    s_add_u32 s64, s64, 0x1000
    s_and_b32 s64, s64, s68
    v_exp_f32 v58, v58
    v_exp_f32 v59, v59
    v_exp_f32 v60, v60
    v_exp_f32 v61, v61
    v_exp_f32 v62, v62
    v_exp_f32 v63, v63
    v_exp_f32 v64, v64
    v_exp_f32 v65, v65
    v_smfmac_f32_32x32x32_bf16 v[16:31], v[208:211], v[56:63], v8
    s_waitcnt vmcnt(12)
    v_exp_f32 v66, v66
    v_exp_f32 v67, v67
    v_exp_f32 v68, v68
    v_exp_f32 v69, v69
    v_mfma_f32_32x32x16_bf16 v[48:63], v[212:215], v[112:115], v[80:95]
    s_nop 0
    v_exp_f32 v70, v70
    v_exp_f32 v71, v71
    v_exp_f32 v72, v72
    v_exp_f32 v73, v73
    v_smfmac_f32_32x32x32_bf16 v[32:47], v[204:207], v[64:71], v8
    s_add_u32 s12, s44, s64
    s_addc_u32 s13, s45, 0
    v_exp_f32 v74, v74
    v_exp_f32 v75, v75
    v_exp_f32 v76, v76
    v_exp_f32 v77, v77
    v_exp_f32 v78, v78
    v_exp_f32 v79, v79
    v_exp_f32 v48, v48
    v_exp_f32 v49, v49
    v_smfmac_f32_32x32x32_bf16 v[32:47], v[208:211], v[72:79], v8
    s_mov_b64 exec, s[70:71]
    global_load_dwordx4 v[180:183], v10, s[12:13] offset:1024 sc1
    global_load_dwordx4 v[184:187], v10, s[12:13] offset:1536 sc1
    s_mov_b64 exec, -1
    v_exp_f32 v50, v50
    v_exp_f32 v51, v51
    v_exp_f32 v52, v52
    v_exp_f32 v53, v53
    v_mfma_f32_32x32x16_bf16 v[64:79], v[212:215], v[116:119], v[96:111]
    global_load_dwordx4 v[176:179], v9, s[12:13] offset:0 sc1
    v_exp_f32 v54, v54
    v_exp_f32 v55, v55
    v_exp_f32 v56, v56
    v_exp_f32 v57, v57
    v_smfmac_f32_32x32x32_bf16 v[16:31], v[216:219], v[48:55], v8
    v_exp_f32 v58, v58
    v_exp_f32 v59, v59
    v_exp_f32 v60, v60
    v_exp_f32 v61, v61
    v_exp_f32 v62, v62
    v_exp_f32 v63, v63
    v_exp_f32 v64, v64
    v_exp_f32 v65, v65
    v_smfmac_f32_32x32x32_bf16 v[16:31], v[220:223], v[56:63], v8
    s_waitcnt vmcnt(12)
    s_add_u32 s65, s65, 1
    v_exp_f32 v66, v66
    v_exp_f32 v67, v67
    v_exp_f32 v68, v68
    v_exp_f32 v69, v69
    v_mfma_f32_32x32x16_bf16 v[48:63], v[128:131], v[112:115], v[80:95]
    s_cmp_lg_u32 s65, 7
    v_exp_f32 v70, v70
    v_exp_f32 v71, v71
    v_exp_f32 v72, v72
    v_exp_f32 v73, v73
    v_smfmac_f32_32x32x32_bf16 v[32:47], v[216:219], v[64:71], v8
    v_exp_f32 v74, v74
    v_exp_f32 v75, v75
    v_exp_f32 v76, v76
    v_exp_f32 v77, v77
    v_exp_f32 v78, v78
    v_exp_f32 v79, v79
    s_cbranch_scc1 L_loop
    v_exp_f32 v48, v48
    v_exp_f32 v49, v49
    v_smfmac_f32_32x32x32_bf16 v[32:47], v[220:223], v[72:79], v8
    s_mov_b64 exec, s[70:71]
    global_load_dwordx4 v[192:195], v10, s[12:13] offset:3072 sc1
    global_load_dwordx4 v[196:199], v10, s[12:13] offset:3584 sc1
    s_mov_b64 exec, -1
    v_exp_f32 v50, v50
    v_exp_f32 v51, v51
    v_exp_f32 v52, v52
    v_exp_f32 v53, v53
    v_mfma_f32_32x32x16_bf16 v[64:79], v[128:131], v[116:119], v[96:111]
    global_load_dwordx4 v[188:191], v9, s[12:13] offset:2048 sc1
    v_exp_f32 v54, v54
    v_exp_f32 v55, v55
    v_exp_f32 v56, v56
    v_exp_f32 v57, v57
    v_smfmac_f32_32x32x32_bf16 v[16:31], v[132:135], v[48:55], v8
    s_add_u32 s64, s64, 0x1000
    s_and_b32 s64, s64, s68
    v_exp_f32 v58, v58
    v_exp_f32 v59, v59
    v_exp_f32 v60, v60
    v_exp_f32 v61, v61
    v_exp_f32 v62, v62
    v_exp_f32 v63, v63
    v_exp_f32 v64, v64
    v_exp_f32 v65, v65
    v_smfmac_f32_32x32x32_bf16 v[16:31], v[136:139], v[56:63], v8
    s_waitcnt vmcnt(12)
    v_exp_f32 v66, v66
    v_exp_f32 v67, v67
    v_exp_f32 v68, v68
    v_exp_f32 v69, v69
    v_mfma_f32_32x32x16_bf16 v[48:63], v[140:143], v[112:115], v[80:95]
    s_nop 0
    v_exp_f32 v70, v70
    v_exp_f32 v71, v71
    v_exp_f32 v72, v72
    v_exp_f32 v73, v73
    v_smfmac_f32_32x32x32_bf16 v[32:47], v[132:135], v[64:71], v8
    s_add_u32 s12, s44, s64
    s_addc_u32 s13, s45, 0
    v_exp_f32 v74, v74
    v_exp_f32 v75, v75
    v_exp_f32 v76, v76
    v_exp_f32 v77, v77
    v_exp_f32 v78, v78
    v_exp_f32 v79, v79
    v_exp_f32 v48, v48
    v_exp_f32 v49, v49
    v_smfmac_f32_32x32x32_bf16 v[32:47], v[136:139], v[72:79], v8
    s_mov_b64 exec, s[70:71]
    global_load_dwordx4 v[204:207], v10, s[12:13] offset:1024 sc1
    global_load_dwordx4 v[208:211], v10, s[12:13] offset:1536 sc1
    s_mov_b64 exec, -1
    v_exp_f32 v50, v50
    v_exp_f32 v51, v51
    v_exp_f32 v52, v52
    v_exp_f32 v53, v53
    v_mfma_f32_32x32x16_bf16 v[64:79], v[140:143], v[116:119], v[96:111]
    global_load_dwordx4 v[200:203], v9, s[12:13] offset:0 sc1
    v_exp_f32 v54, v54
    v_exp_f32 v55, v55
    v_exp_f32 v56, v56
    v_exp_f32 v57, v57
    v_smfmac_f32_32x32x32_bf16 v[16:31], v[144:147], v[48:55], v8
    v_exp_f32 v58, v58
    v_exp_f32 v59, v59
    v_exp_f32 v60, v60
    v_exp_f32 v61, v61
    v_exp_f32 v62, v62
    v_exp_f32 v63, v63
    v_exp_f32 v64, v64
    v_exp_f32 v65, v65
    v_smfmac_f32_32x32x32_bf16 v[16:31], v[148:151], v[56:63], v8
    s_waitcnt vmcnt(12)
    v_exp_f32 v66, v66
    v_exp_f32 v67, v67
    v_exp_f32 v68, v68
    v_exp_f32 v69, v69
    v_mfma_f32_32x32x16_bf16 v[48:63], v[152:155], v[112:115], v[80:95]
    s_nop 0
    v_exp_f32 v70, v70
    v_exp_f32 v71, v71
    v_exp_f32 v72, v72
    v_exp_f32 v73, v73
    v_smfmac_f32_32x32x32_bf16 v[32:47], v[144:147], v[64:71], v8
    v_exp_f32 v74, v74
    v_exp_f32 v75, v75
    v_exp_f32 v76, v76
    v_exp_f32 v77, v77
    v_exp_f32 v78, v78
    v_exp_f32 v79, v79
    v_exp_f32 v48, v48
    v_exp_f32 v49, v49
    v_smfmac_f32_32x32x32_bf16 v[32:47], v[148:151], v[72:79], v8
    s_mov_b64 exec, s[70:71]
    global_load_dwordx4 v[216:219], v10, s[12:13] offset:3072 sc1
    global_load_dwordx4 v[220:223], v10, s[12:13] offset:3584 sc1
    s_mov_b64 exec, -1
    v_exp_f32 v50, v50
    v_exp_f32 v51, v51
    v_exp_f32 v52, v52
    v_exp_f32 v53, v53
    v_mfma_f32_32x32x16_bf16 v[64:79], v[152:155], v[116:119], v[96:111]
    global_load_dwordx4 v[212:215], v9, s[12:13] offset:2048 sc1
    v_exp_f32 v54, v54
    v_exp_f32 v55, v55
    v_exp_f32 v56, v56
    v_exp_f32 v57, v57
    v_smfmac_f32_32x32x32_bf16 v[16:31], v[156:159], v[48:55], v8
    s_add_u32 s64, s64, 0x1000
    s_and_b32 s64, s64, s68
    v_exp_f32 v58, v58
    v_exp_f32 v59, v59
    v_exp_f32 v60, v60
    v_exp_f32 v61, v61
    v_exp_f32 v62, v62
    v_exp_f32 v63, v63
    v_exp_f32 v64, v64
    v_exp_f32 v65, v65
    v_smfmac_f32_32x32x32_bf16 v[16:31], v[160:163], v[56:63], v8
    s_waitcnt vmcnt(12)
    v_exp_f32 v66, v66
    v_exp_f32 v67, v67
    v_exp_f32 v68, v68
    v_exp_f32 v69, v69
    v_mfma_f32_32x32x16_bf16 v[48:63], v[164:167], v[112:115], v[80:95]
    s_nop 0
    v_exp_f32 v70, v70
    v_exp_f32 v71, v71
    v_exp_f32 v72, v72
    v_exp_f32 v73, v73
    v_smfmac_f32_32x32x32_bf16 v[32:47], v[156:159], v[64:71], v8
    s_add_u32 s12, s44, s64
    s_addc_u32 s13, s45, 0
    v_exp_f32 v74, v74
    v_exp_f32 v75, v75
    v_exp_f32 v76, v76
    v_exp_f32 v77, v77
    v_exp_f32 v78, v78
    v_exp_f32 v79, v79
    v_exp_f32 v48, v48
    v_exp_f32 v49, v49
    v_smfmac_f32_32x32x32_bf16 v[32:47], v[160:163], v[72:79], v8
    v_exp_f32 v50, v50
    v_exp_f32 v51, v51
    v_exp_f32 v52, v52
    v_exp_f32 v53, v53
    v_mfma_f32_32x32x16_bf16 v[64:79], v[164:167], v[116:119], v[96:111]
    s_nop 0
    v_exp_f32 v54, v54
    v_exp_f32 v55, v55
    v_exp_f32 v56, v56
    v_exp_f32 v57, v57
    v_smfmac_f32_32x32x32_bf16 v[16:31], v[168:171], v[48:55], v8
    v_exp_f32 v58, v58
    v_exp_f32 v59, v59
    v_exp_f32 v60, v60
    v_exp_f32 v61, v61
    v_exp_f32 v62, v62
    v_exp_f32 v63, v63
    v_exp_f32 v64, v64
    v_exp_f32 v65, v65
    v_smfmac_f32_32x32x32_bf16 v[16:31], v[172:175], v[56:63], v8
    s_waitcnt vmcnt(9)
    v_exp_f32 v66, v66
    v_exp_f32 v67, v67
    v_exp_f32 v68, v68
    v_exp_f32 v69, v69
    v_mfma_f32_32x32x16_bf16 v[48:63], v[176:179], v[112:115], v[80:95]
    s_nop 0
    v_exp_f32 v70, v70
    v_exp_f32 v71, v71
    v_exp_f32 v72, v72
    v_exp_f32 v73, v73
    v_smfmac_f32_32x32x32_bf16 v[32:47], v[168:171], v[64:71], v8
    v_exp_f32 v74, v74
    v_exp_f32 v75, v75
    v_exp_f32 v76, v76
    v_exp_f32 v77, v77
    v_exp_f32 v78, v78
    v_exp_f32 v79, v79
    v_exp_f32 v48, v48
    v_exp_f32 v49, v49
    v_smfmac_f32_32x32x32_bf16 v[32:47], v[172:175], v[72:79], v8
    v_exp_f32 v50, v50
    v_exp_f32 v51, v51
    v_exp_f32 v52, v52
    v_exp_f32 v53, v53
    v_mfma_f32_32x32x16_bf16 v[64:79], v[176:179], v[116:119], v[96:111]
    s_nop 0
    v_exp_f32 v54, v54
    v_exp_f32 v55, v55
    v_exp_f32 v56, v56
    v_exp_f32 v57, v57
    v_smfmac_f32_32x32x32_bf16 v[16:31], v[180:183], v[48:55], v8
    v_exp_f32 v58, v58
    v_exp_f32 v59, v59
    v_exp_f32 v60, v60
    v_exp_f32 v61, v61
    v_exp_f32 v62, v62
    v_exp_f32 v63, v63
    v_exp_f32 v64, v64
    v_exp_f32 v65, v65
    v_smfmac_f32_32x32x32_bf16 v[16:31], v[184:187], v[56:63], v8
    s_waitcnt vmcnt(6)
    v_exp_f32 v66, v66
    v_exp_f32 v67, v67
    v_exp_f32 v68, v68
    v_exp_f32 v69, v69
    v_mfma_f32_32x32x16_bf16 v[48:63], v[188:191], v[112:115], v[80:95]
    s_nop 0
    v_exp_f32 v70, v70
    v_exp_f32 v71, v71
    v_exp_f32 v72, v72
    v_exp_f32 v73, v73
    v_smfmac_f32_32x32x32_bf16 v[32:47], v[180:183], v[64:71], v8
    v_exp_f32 v74, v74
    v_exp_f32 v75, v75
    v_exp_f32 v76, v76
    v_exp_f32 v77, v77
    v_exp_f32 v78, v78
    v_exp_f32 v79, v79
    v_exp_f32 v48, v48
    v_exp_f32 v49, v49
    v_smfmac_f32_32x32x32_bf16 v[32:47], v[184:187], v[72:79], v8
    v_exp_f32 v50, v50
    v_exp_f32 v51, v51
    v_exp_f32 v52, v52
    v_exp_f32 v53, v53
    v_mfma_f32_32x32x16_bf16 v[64:79], v[188:191], v[116:119], v[96:111]
    s_nop 0
    v_exp_f32 v54, v54
    v_exp_f32 v55, v55
    v_exp_f32 v56, v56
    v_exp_f32 v57, v57
    v_smfmac_f32_32x32x32_bf16 v[16:31], v[192:195], v[48:55], v8
    v_exp_f32 v58, v58
    v_exp_f32 v59, v59
    v_exp_f32 v60, v60
    v_exp_f32 v61, v61
    v_exp_f32 v62, v62
    v_exp_f32 v63, v63
    v_exp_f32 v64, v64
    v_exp_f32 v65, v65
    v_smfmac_f32_32x32x32_bf16 v[16:31], v[196:199], v[56:63], v8
    s_waitcnt vmcnt(3)
    v_exp_f32 v66, v66
    v_exp_f32 v67, v67
    v_exp_f32 v68, v68
    v_exp_f32 v69, v69
    v_mfma_f32_32x32x16_bf16 v[48:63], v[200:203], v[112:115], v[80:95]
    s_nop 0
    v_exp_f32 v70, v70
    v_exp_f32 v71, v71
    v_exp_f32 v72, v72
    v_exp_f32 v73, v73
    v_smfmac_f32_32x32x32_bf16 v[32:47], v[192:195], v[64:71], v8
    v_exp_f32 v74, v74
    v_exp_f32 v75, v75
    v_exp_f32 v76, v76
    v_exp_f32 v77, v77
    v_exp_f32 v78, v78
    v_exp_f32 v79, v79
    v_exp_f32 v48, v48
    v_exp_f32 v49, v49
    v_smfmac_f32_32x32x32_bf16 v[32:47], v[196:199], v[72:79], v8
    v_exp_f32 v50, v50
    v_exp_f32 v51, v51
    v_exp_f32 v52, v52
    v_exp_f32 v53, v53
    v_mfma_f32_32x32x16_bf16 v[64:79], v[200:203], v[116:119], v[96:111]
    s_nop 0
    v_exp_f32 v54, v54
    v_exp_f32 v55, v55
    v_exp_f32 v56, v56
    v_exp_f32 v57, v57
    v_smfmac_f32_32x32x32_bf16 v[16:31], v[204:207], v[48:55], v8
    v_exp_f32 v58, v58
    v_exp_f32 v59, v59
    v_exp_f32 v60, v60
    v_exp_f32 v61, v61
    v_exp_f32 v62, v62
    v_exp_f32 v63, v63
    v_exp_f32 v64, v64
    v_exp_f32 v65, v65
    v_smfmac_f32_32x32x32_bf16 v[16:31], v[208:211], v[56:63], v8
    s_waitcnt vmcnt(0)
    v_exp_f32 v66, v66
    v_exp_f32 v67, v67
    v_exp_f32 v68, v68
    v_exp_f32 v69, v69
    v_mfma_f32_32x32x16_bf16 v[48:63], v[212:215], v[112:115], v[80:95]
    s_nop 0
    v_exp_f32 v70, v70
    v_exp_f32 v71, v71
    v_exp_f32 v72, v72
    v_exp_f32 v73, v73
    v_smfmac_f32_32x32x32_bf16 v[32:47], v[204:207], v[64:71], v8
    v_exp_f32 v74, v74
    v_exp_f32 v75, v75
    v_exp_f32 v76, v76
    v_exp_f32 v77, v77
    v_exp_f32 v78, v78
    v_exp_f32 v79, v79
    v_exp_f32 v48, v48
    v_exp_f32 v49, v49
    v_smfmac_f32_32x32x32_bf16 v[32:47], v[208:211], v[72:79], v8
    v_exp_f32 v50, v50
    v_exp_f32 v51, v51
    v_exp_f32 v52, v52
    v_exp_f32 v53, v53
    v_mfma_f32_32x32x16_bf16 v[64:79], v[212:215], v[116:119], v[96:111]
    s_nop 0
    v_exp_f32 v54, v54
    v_exp_f32 v55, v55
    v_exp_f32 v56, v56
    v_exp_f32 v57, v57
    v_smfmac_f32_32x32x32_bf16 v[16:31], v[216:219], v[48:55], v8
    v_exp_f32 v58, v58
    v_exp_f32 v59, v59
    v_exp_f32 v60, v60
    v_exp_f32 v61, v61
    v_exp_f32 v62, v62
    v_exp_f32 v63, v63
    v_exp_f32 v64, v64
    v_exp_f32 v65, v65
    v_smfmac_f32_32x32x32_bf16 v[16:31], v[220:223], v[56:63], v8
    v_exp_f32 v66, v66
    v_exp_f32 v67, v67
    v_exp_f32 v68, v68
    v_exp_f32 v69, v69
    v_exp_f32 v70, v70
    v_exp_f32 v71, v71
    v_exp_f32 v72, v72
    v_exp_f32 v73, v73
    v_smfmac_f32_32x32x32_bf16 v[32:47], v[216:219], v[64:71], v8
    v_exp_f32 v74, v74
    v_exp_f32 v75, v75
    v_exp_f32 v76, v76
    v_exp_f32 v77, v77
    v_exp_f32 v78, v78
    v_exp_f32 v79, v79
    v_lshlrev_b32 v4, 4, v1
    v_rcp_f32 v6, v24
    v_smfmac_f32_32x32x32_bf16 v[32:47], v[220:223], v[72:79], v8
    s_mov_b32 s57, 0x53800000
    s_lshl2_add_u32 s60, s49, s72
    s_lshl_b32 s61, s52, 6
    s_add_u32 s61, s61, s60
    s_lshl_b32 s61, s61, 10
    s_add_u32 s61, s61, 8388608
    s_add_u32 s62, s61, 0x8000
    v_mul_f32 v64, v6, v16
    v_mul_f32 v65, v6, v17
    v_mul_f32 v66, v6, v18
    v_mul_f32 v67, v6, v19
    v_mul_f32 v68, v6, v20
    v_mul_f32 v69, v6, v21
    v_mul_f32 v70, v6, v22
    v_mul_f32 v71, v6, v23
    v_rcp_f32 v7, v40
    v_cmp_nle_f32 vcc, v24, s57
    v_cmp_nle_f32 s[58:59], v40, s57
    v_cvt_pk_bf16_f32 v48, v64, v65
    v_cvt_pk_bf16_f32 v49, v66, v67
    v_cvt_pk_bf16_f32 v50, v68, v69
    v_cvt_pk_bf16_f32 v51, v70, v71
    s_or_b64 vcc, vcc, s[58:59]
    s_cbranch_vccnz L_fallback
L_attn_done:
    buffer_store_dwordx4 v[48:51], v4, s[44:47], s61 offen sc1
    v_mul_f32 v64, v7, v32
    v_mul_f32 v65, v7, v33
    v_mul_f32 v66, v7, v34
    v_mul_f32 v67, v7, v35
    v_mul_f32 v68, v7, v36
    v_mul_f32 v69, v7, v37
    v_mul_f32 v70, v7, v38
    v_mul_f32 v71, v7, v39
    v_cvt_pk_bf16_f32 v52, v64, v65
    v_cvt_pk_bf16_f32 v53, v66, v67
    v_cvt_pk_bf16_f32 v54, v68, v69
    v_cvt_pk_bf16_f32 v55, v70, v71
    buffer_store_dwordx4 v[52:55], v4, s[44:47], s62 offen sc1
    v_lshlrev_b32 v6, 9, v1
    v_mov_b32 v7, s54
    s_barrier
    s_lshr_b32 s57, s52, 2
    s_lshl3_add_u32 s61, s49, s57
    s_lshl2_add_u32 s61, s61, s72
    s_lshl_b32 s56, s61, 7
    s_add_u32 s56, s56, 10584064
    s_mov_b32 s70, s54
    s_mov_b32 s71, s54
    s_mov_b32 s67, 0
    s_load_dwordx8 s[4:11], s[44:45], s56 glc
    s_mov_b32 s59, s60
    s_lshr_b32 s57, s59, 3
    s_mul_i32 s57, s57, 96
    s_lshl2_add_u32 s57, s59, s57
    s_lshl_b32 s60, s52, 10
    s_add_u32 s60, s60, 10584064
    s_add_u32 s57, s57, s60
    s_lshl_b32 s61, s61, 13
    s_add_u32 s61, s61, 8388608
    s_add_u32 s62, s61, 0x1000
    s_lshl_b32 m0, s72, 13
    v_lshlrev_b32 v3, s72, v3
    s_mov_b64 exec, 3
    s_waitcnt vmcnt(0)
    buffer_store_dword v7, v6, s[44:47], s57 offen sc1
    s_mov_b64 exec, -1
    s_branch L_spoll20b
L_spoll20:
    s_load_dwordx8 s[4:11], s[44:45], s56 glc
L_spoll20b:
    s_add_u32 s67, s67, 1
    s_cmp_ge_u32 s67, 16384
    s_waitcnt lgkmcnt(0)
    s_cbranch_scc1 L_spollok21
    s_xor_b64 s[4:5], s[4:5], s[70:71]
    s_xor_b64 s[6:7], s[6:7], s[70:71]
    s_xor_b64 s[8:9], s[8:9], s[70:71]
    s_xor_b64 s[10:11], s[10:11], s[70:71]
    s_or_b64 s[4:5], s[4:5], s[6:7]
    s_or_b64 s[8:9], s[8:9], s[10:11]
    s_or_b64 s[4:5], s[4:5], s[8:9]
    s_cbranch_scc0 L_spollok21
    s_sleep 1
    s_branch L_spoll20
L_spollok21:
    buffer_load_dwordx4 v4, s[44:47], s61 offen offset:0 sc1 lds
    buffer_load_dwordx4 v4, s[44:47], s61 offen offset:1024 sc1 lds
    buffer_load_dwordx4 v4, s[44:47], s61 offen offset:2048 sc1 lds
    buffer_load_dwordx4 v4, s[44:47], s61 offen offset:3072 sc1 lds
    s_addk_i32 m0, 0x1000
    s_nop 0
    buffer_load_dwordx4 v4, s[44:47], s62 offen offset:0 sc1 lds
    buffer_load_dwordx4 v4, s[44:47], s62 offen offset:1024 sc1 lds
    buffer_load_dwordx4 v4, s[44:47], s62 offen offset:2048 sc1 lds
    buffer_load_dwordx4 v4, s[44:47], s62 offen offset:3072 sc1 lds
    s_mov_b64 exec, 1
    s_waitcnt vmcnt(0)
    ds_or_b32 v2, v3 offset:4
    s_endpgm
L_fallback:
    s_cmp_lg_u32 s66, 0
    s_cbranch_scc1 L_attn_done
    s_mov_b32 s66, 1
    s_mov_b32 s64, 0
    v_mov_b32 v6, 0xff800000
    v_mov_b32 v7, v6
    v_mov_b64 v[16:17], 0
    v_mov_b64 v[18:19], 0
    v_mov_b64 v[20:21], 0
    v_mov_b64 v[22:23], 0
    v_mov_b64 v[24:25], 0
    v_mov_b64 v[26:27], 0
    v_mov_b64 v[28:29], 0
    v_mov_b64 v[30:31], 0
    v_mov_b64 v[32:33], 0
    v_mov_b64 v[34:35], 0
    v_mov_b64 v[36:37], 0
    v_mov_b64 v[38:39], 0
    v_mov_b64 v[40:41], 0
    v_mov_b64 v[42:43], 0
    v_mov_b64 v[44:45], 0
    v_mov_b64 v[46:47], 0
    s_waitcnt vmcnt(0)
L_fb:
    buffer_load_dwordx4 v[128:131], v9, s[44:47], s64 offen sc1
    s_add_u32 s64, s64, 0x800
    s_waitcnt vmcnt(0)
    v_mfma_f32_32x32x16_bf16 v[48:63], v[128:131], v[112:115], 0
    v_mfma_f32_32x32x16_bf16 v[64:79], v[128:131], v[116:119], 0
    s_nop 10
    v_max3_f32 v6, v6, v48, v49
    v_max3_f32 v6, v6, v50, v51
    v_max3_f32 v6, v6, v52, v53
    v_max3_f32 v6, v6, v54, v55
    v_max3_f32 v6, v6, v56, v57
    v_max3_f32 v6, v6, v58, v59
    v_max3_f32 v6, v6, v60, v61
    v_max3_f32 v6, v6, v62, v63
    v_max3_f32 v7, v7, v64, v65
    v_max3_f32 v7, v7, v66, v67
    v_max3_f32 v7, v7, v68, v69
    v_max3_f32 v7, v7, v70, v71
    v_max3_f32 v7, v7, v72, v73
    v_max3_f32 v7, v7, v74, v75
    v_max3_f32 v7, v7, v76, v77
    v_max3_f32 v7, v7, v78, v79
    s_cmp_lg_u32 s64, 0x20000
    s_cbranch_scc1 L_fb
    s_lshl_b32 s64, s52, 12
    s_add_u32 s12, s44, s64
    s_addc_u32 s13, s45, 0
    global_load_dwordx4 v[128:131], v9, s[12:13] offset:0 sc1
    s_mov_b64 exec, s[70:71]
    global_load_dwordx4 v[132:135], v10, s[12:13] offset:1024 sc1
    global_load_dwordx4 v[136:139], v10, s[12:13] offset:1536 sc1
    s_mov_b64 exec, -1
    global_load_dwordx4 v[140:143], v9, s[12:13] offset:2048 sc1
    s_mov_b64 exec, s[70:71]
    global_load_dwordx4 v[144:147], v10, s[12:13] offset:3072 sc1
    global_load_dwordx4 v[148:151], v10, s[12:13] offset:3584 sc1
    s_mov_b64 exec, -1
    s_add_u32 s64, s64, 0x1000
    s_and_b32 s64, s64, s68
    s_add_u32 s12, s44, s64
    s_addc_u32 s13, s45, 0
    global_load_dwordx4 v[152:155], v9, s[12:13] offset:0 sc1
    s_mov_b64 exec, s[70:71]
    global_load_dwordx4 v[156:159], v10, s[12:13] offset:1024 sc1
    global_load_dwordx4 v[160:163], v10, s[12:13] offset:1536 sc1
    s_mov_b64 exec, -1
    global_load_dwordx4 v[164:167], v9, s[12:13] offset:2048 sc1
    s_mov_b64 exec, s[70:71]
    global_load_dwordx4 v[168:171], v10, s[12:13] offset:3072 sc1
    global_load_dwordx4 v[172:175], v10, s[12:13] offset:3584 sc1
    s_mov_b64 exec, -1
    s_add_u32 s64, s64, 0x1000
    s_and_b32 s64, s64, s68
    s_add_u32 s12, s44, s64
    s_addc_u32 s13, s45, 0
    global_load_dwordx4 v[176:179], v9, s[12:13] offset:0 sc1
    s_mov_b64 exec, s[70:71]
    global_load_dwordx4 v[180:183], v10, s[12:13] offset:1024 sc1
    global_load_dwordx4 v[184:187], v10, s[12:13] offset:1536 sc1
    s_mov_b64 exec, -1
    v_mov_b32 v4, v6
    v_mov_b32 v11, v7
    s_nop 0
    v_permlane32_swap_b32 v6, v4
    v_permlane32_swap_b32 v7, v11
    v_max_f32 v6, v6, v4
    v_max_f32 v7, v7, v11
    v_sub_f32 v80, 0, v6
    v_sub_f32 v96, 0, v7
    v_sub_f32 v81, 0, v6
    v_sub_f32 v97, 0, v7
    v_sub_f32 v82, 0, v6
    v_sub_f32 v98, 0, v7
    v_sub_f32 v83, 0, v6
    v_sub_f32 v99, 0, v7
    v_sub_f32 v84, 0, v6
    v_sub_f32 v100, 0, v7
    v_sub_f32 v85, 0, v6
    v_sub_f32 v101, 0, v7
    v_sub_f32 v86, 0, v6
    v_sub_f32 v102, 0, v7
    v_sub_f32 v87, 0, v6
    v_sub_f32 v103, 0, v7
    v_sub_f32 v88, 0, v6
    v_sub_f32 v104, 0, v7
    v_sub_f32 v89, 0, v6
    v_sub_f32 v105, 0, v7
    v_sub_f32 v90, 0, v6
    v_sub_f32 v106, 0, v7
    v_sub_f32 v91, 0, v6
    v_sub_f32 v107, 0, v7
    v_sub_f32 v92, 0, v6
    v_sub_f32 v108, 0, v7
    v_sub_f32 v93, 0, v6
    v_sub_f32 v109, 0, v7
    v_sub_f32 v94, 0, v6
    v_sub_f32 v110, 0, v7
    v_sub_f32 v95, 0, v6
    v_sub_f32 v111, 0, v7
    v_mov_b64 v[72:73], 0
    v_mov_b64 v[74:75], 0
    v_mov_b64 v[76:77], 0
    v_mov_b64 v[78:79], 0
    s_mov_b32 s65, 0
    s_waitcnt vmcnt(0)
    v_mfma_f32_32x32x16_bf16 v[48:63], v[128:131], v[112:115], v[80:95]
    s_nop 11
    s_branch L_fill
L_end:
    s_endpgm
.section .rodata,"a"
.p2align 6
.amdhsa_kernel concat_heads__mha_block__ssm_conv_h3__prompt_kernel
  .amdhsa_next_free_vgpr 256
  .amdhsa_next_free_sgpr 102
  .amdhsa_accum_offset 256
  .amdhsa_group_segment_fixed_size 0
  .amdhsa_kernarg_size 96
  .amdhsa_user_sgpr_count 2
  .amdhsa_user_sgpr_kernarg_segment_ptr 1
  .amdhsa_system_sgpr_workgroup_id_x 1
.end_amdhsa_kernel
```
